```python
import torch

def _softmax(x, axis=-1):
    return torch.softmax(x, dim=axis)

def _gelu(x):
    return torch.nn.functional.gelu(x, approximate='tanh')

def _silu(x):
    return torch.nn.functional.silu(x)

def _sigmoid(x):
    return torch.sigmoid(x)

def _layernorm(x, axis=-1, eps=1e-05):
    m = x.mean(dim=axis, keepdim=True)
    v = x.var(dim=axis, keepdim=True, unbiased=False)
    return (x - m) / torch.sqrt(v + eps)

def _scatter_add(tgt, idx, src, axis=0):
    return tgt.clone().index_add_(axis, idx, src)

def _segment_sum(src, seg, n):
    out = torch.zeros((n,) + src.shape[1:], dtype=src.dtype)
    return out.index_add_(0, seg, src)

def _pad(x, pw):
    flat = tuple((v for pair in reversed(pw) for v in pair))
    return torch.nn.functional.pad(x, flat)
kernel_name = 'adaLN_cond__softmax_full_mha__mixer_gmlp__prompt'

def setup_inputs():

    _w = lambda a: (lambda t: t.to(torch.bfloat16) if t.is_floating_point() else t)(torch.as_tensor(a))

    def _A_setup():
        B, S, D = (1, 2048, 512)
        return {'x': _w((lambda *s: torch.randn(*s, dtype=torch.bfloat16) * 0.05)(B, S, D)), 'wqkv': _w((lambda *s: torch.randn(*s, dtype=torch.bfloat16) * 0.05)(D, 3 * D)), 'wo': _w((lambda *s: torch.randn(*s, dtype=torch.bfloat16) * 0.05)(D, D))}
    _A_in = _A_setup()

    def _B_setup():
        B, S, D, F = (1, 2048, 512, 1792)
        Fh = F // 2
        return {'x': _w((lambda *s: torch.randn(*s, dtype=torch.bfloat16) * 0.05)(B, S, D)), 'w_in': _w((lambda *s: torch.randn(*s, dtype=torch.bfloat16) * 0.4)(D, 2 * Fh)), 'w_sp': _w(0.01 * (lambda *s: torch.randn(*s, dtype=torch.bfloat16) * 0.4)(S, S)), 'b_sp': _w(1.0 + 0.01 * (lambda *s: torch.randn(*s, dtype=torch.bfloat16) * 0.05)(S)), 'w_out': _w((lambda *s: torch.randn(*s, dtype=torch.bfloat16) * 0.05)(Fh, D))}
    _B_in = _B_setup()
    return {'A_x': _A_in['x'], 'A_wqkv': _A_in['wqkv'], 'A_wo': _A_in['wo'], 'B_x': _B_in['x'], 'B_w_in': _B_in['w_in'], 'B_w_sp': _B_in['w_sp'], 'B_b_sp': _B_in['b_sp'], 'B_w_out': _B_in['w_out'], 'c': _w((lambda *s: torch.randn(*s, dtype=torch.bfloat16) * 0.1)(1, 512) * 8.0), 'w_mod': _w((lambda *s: torch.randn(*s, dtype=torch.bfloat16) * 0.1)(512, 6 * 512) * 512 ** (-0.5) * 8.0)}

def reference(A_x, A_wqkv, A_wo, B_x, B_w_in, B_w_sp, B_b_sp, B_w_out, c, w_mod):

    def _A_ref(x, wqkv, wo):
        B, S, D = x.shape
        H = 32
        Dh = D // H
        qkv = (lambda x, *d: x.permute(*d))((x @ wqkv).reshape(B, S, 3, H, Dh), 2, 0, 3, 1, 4)
        q, k, v = (qkv[0], qkv[1], qkv[2])
        scale = Dh ** (-0.5)
        scores = torch.einsum('bhqd,bhkd->bhqk', q, k) * scale
        p = _softmax(scores, axis=-1)
        o = torch.einsum('bhqk,bhkd->bhqd', p, v)
        return (lambda x, *d: x.permute(*d))(o, 0, 2, 1, 3).reshape(B, S, D) @ wo

    def _B_ref(x, w_in, w_sp, b_sp, w_out):
        B, S, D = x.shape
        F = w_in.shape[-1]
        Fh = F // 2
        z = _gelu(torch.einsum('bsd,df->bsf', x, w_in))
        z1 = z[..., :Fh].clone()
        z2 = _layernorm(z[..., Fh:], axis=-1)
        g = torch.einsum('ts,bsf->btf', w_sp, z2) + b_sp[None, :, None]
        return torch.einsum('bsf,fd->bsd', z1 * g, w_out)
    x = A_x
    mod = (_silu(c) @ w_mod).reshape(c.shape[0], 6, 1, -1)
    sa, ca, ga, sb, cb, gb = (mod[:, 0].clone(), mod[:, 1].clone(), mod[:, 2].clone(), mod[:, 3].clone(), mod[:, 4].clone(), mod[:, 5].clone())
    h = _layernorm(x, axis=-1) * (1 + ca) + sa
    x = x + ga * _A_ref(h, A_wqkv, A_wo)
    h = _layernorm(x, axis=-1) * (1 + cb) + sb
    x = x + gb * _B_ref(h, B_w_in, B_w_sp, B_b_sp, B_w_out)
    return x
```

```asm
; @launch grid=(256,1,1) block=(512,1,1) lds=163840
.amdgcn_target "amdgcn-amd-amdhsa--gfx950"
.text
.globl adaLN_cond__softmax_full_mha__mixer_gmlp__prompt_kernel
.p2align 8
.type adaLN_cond__softmax_full_mha__mixer_gmlp__prompt_kernel,@function
adaLN_cond__softmax_full_mha__mixer_gmlp__prompt_kernel:
    s_cmp_ge_u32 s2, 256
    s_cbranch_scc1 L_exit
    s_load_dwordx16 s[64:79], s[0:1], 0
    s_load_dwordx8 s[80:87], s[0:1], 64
    s_load_dwordx2 s[88:89], s[0:1], 96
    v_and_b32 v1, 63, v0
    v_lshrrev_b32 v2, 6, v0
    s_nop 0
    v_readfirstlane_b32 s3, v2
    s_and_b32 s20, s2, 7
    s_lshr_b32 s21, s2, 3
    s_and_b32 s4, s20, 3
    s_lshl_b32 s4, s4, 3
    s_and_b32 s22, s21, 7
    s_add_u32 s4, s4, s22
    s_lshr_b32 s5, s20, 2
    s_lshl_b32 s5, s5, 2
    s_lshr_b32 s22, s21, 3
    s_add_u32 s5, s5, s22
    s_lshl_b32 s58, s20, 2
    s_and_b32 s22, s21, 3
    s_add_u32 s58, s58, s22
    s_lshr_b32 s57, s21, 2
    s_waitcnt lgkmcnt(0)
    s_add_u32 s60, s88, 0x60000
    s_addc_u32 s61, s89, 0
    s_mov_b32 s62, 0x10000
    s_mov_b32 s63, 0x20000
    s_cmp_lg_u32 s3, 7
    s_cbranch_scc1 nn_1
    s_mov_b32 s8, s86
    s_mov_b32 s9, s87
    s_mov_b32 s10, 0x100
    s_mov_b32 s11, 0x20000
    v_mov_b32 v251, 0
    s_cmp_lg_u32 s2, 0
    s_cbranch_scc1 ng_2
    s_memrealtime s[46:47]
    s_waitcnt lgkmcnt(0)
    s_or_b32 s46, s46, 1
    v_mov_b32 v250, s46
    s_mov_b64 exec, 1
    buffer_store_dword v250, v251, s[8:11], 0 offen sc1
    s_mov_b64 exec, -1
ng_2:
nn_1:
    s_mov_b32 s8, s64
    s_mov_b32 s9, s65
    s_mov_b32 s10, 0x200000
    s_mov_b32 s11, 0x20000
    s_mov_b32 s12, s88
    s_mov_b32 s13, s89
    s_mov_b32 s14, 0xc000
    s_mov_b32 s15, 0x20000
    s_mov_b32 s16, s66
    s_mov_b32 s17, s67
    s_mov_b32 s18, 0x180000
    s_mov_b32 s19, 0x20000
    s_add_u32 s24, s88, 0x100000
    s_addc_u32 s25, s89, 0
    s_mov_b32 s26, 0x400000
    s_mov_b32 s27, 0x20000
    s_add_u32 s28, s88, 0x500000
    s_addc_u32 s29, s89, 0
    s_mov_b32 s30, 0x200000
    s_mov_b32 s31, 0x20000
    s_mov_b32 s32, s82
    s_mov_b32 s33, s83
    s_mov_b32 s34, 0x300000
    s_mov_b32 s35, 0x20000
    s_mov_b32 s36, s80
    s_mov_b32 s37, s81
    s_mov_b32 s38, 0x400
    s_mov_b32 s39, 0x20000
    s_sub_u32 s20, s2, 0
    s_cmp_ge_u32 s20, 64
    s_cbranch_scc1 nomod_3
    v_and_b32 v72, 7, v0
    v_lshrrev_b32 v73, 3, v0
    v_mul_u32_u24 v74, 6144, v73
    v_lshl_add_u32 v74, v72, 4, v74
    v_lshlrev_b32 v75, 1, v73
    s_and_b32 s20, s2, 3
    s_lshr_b32 s21, s2, 2
    s_mul_i32 s40, s20, 786432
    s_lshl_b32 s21, s21, 7
    s_add_u32 s40, s40, s21
    s_add_u32 s41, s40, 393216
    s_lshl_b32 s42, s20, 8
    buffer_load_dwordx4 v[80:83], v74, s[32:35], s40 offen
    buffer_load_dwordx4 v[84:87], v74, s[32:35], s41 offen
    buffer_load_ushort v76, v75, s[36:39], s42 offen
    buffer_load_ushort v77, v75, s[36:39], s42 offen offset:128
    s_barrier
nomod_3:
    s_cmp_lg_u32 s3, 7
    s_cbranch_scc1 gn_4
    s_mov_b32 s48, s86
    s_mov_b32 s49, s87
    s_mov_b32 s50, 0x100
    s_mov_b32 s51, 0x20000
    v_mov_b32 v251, 0
    s_mov_b32 s47, 0
gnp_5:
    buffer_load_dword v250, v251, s[48:51], 0 offen sc0 sc1
    s_add_u32 s47, s47, 1
    s_cmp_gt_u32 s47, 1048576
    s_cbranch_scc1 gnd_6
    s_waitcnt vmcnt(0)
    v_readfirstlane_b32 s59, v250
    s_nop 3
    s_cmp_eq_u32 s59, 0
    s_cbranch_scc1 gnp_5
gnd_6:
    ds_write_b32 v251, v250
    s_waitcnt lgkmcnt(0)
gn_4:
    s_lshl_b32 s6, s4, 16
    v_lshrrev_b32 v3, 4, v1
    v_and_b32 v4, 15, v1
    s_lshl_b32 s20, s3, 3
    v_add_u32 v5, s20, v3
    v_lshlrev_b32 v5, 10, v5
    v_lshl_add_u32 v5, v4, 4, v5
    s_add_u32 s21, s6, 4096
    buffer_load_dwordx4 v[32:35], v5, s[8:11], s6 offen offset:0
    buffer_load_dwordx4 v[36:39], v5, s[8:11], s6 offen offset:256
    buffer_load_dwordx4 v[40:43], v5, s[8:11], s6 offen offset:512
    buffer_load_dwordx4 v[44:47], v5, s[8:11], s6 offen offset:768
    buffer_load_dwordx4 v[48:51], v5, s[8:11], s21 offen offset:0
    buffer_load_dwordx4 v[52:55], v5, s[8:11], s21 offen offset:256
    buffer_load_dwordx4 v[56:59], v5, s[8:11], s21 offen offset:512
    buffer_load_dwordx4 v[60:63], v5, s[8:11], s21 offen offset:768
    s_cmp_ge_u32 s3, 3
    s_cbranch_scc1 touch_7
    s_and_b32 s20, s4, 7
    s_lshl_b32 s20, s20, 6
    v_add_u32 v7, s20, v1
    v_mul_u32_u24 v7, 3072, v7
    s_lshl_b32 s20, s5, 8
    s_lshl_b32 s21, s3, 7
    s_add_u32 s20, s20, s21
    s_lshl_b32 s21, s5, 7
    s_add_u32 s21, s21, 2048
    s_cmp_eq_u32 s3, 2
    s_cselect_b32 s20, s21, s20
    buffer_load_dword v9, v7, s[16:19], s20 offen
touch_7:
    s_and_b32 s7, s3, 3
    s_lshl_b32 s20, s7, 6
    s_add_u32 s20, s20, 0
    v_add_u32 v200, s20, v1
    v_mul_u32_u24 v201, 2731, v200
    v_lshrrev_b32 v201, 16, v201
    v_mul_u32_u24 v202, 24, v201
    v_sub_u32 v202, v200, v202
    v_bfe_u32 v203, v201, 1, 1
    v_bfe_u32 v204, v201, 3, 1
    v_lshl_or_b32 v203, v204, 1, v203
    v_lshlrev_b32 v203, 1, v203
    v_xor_b32 v202, v202, v203
    v_lshlrev_b32 v203, 4, v202
    s_lshl_b32 s20, s5, 8
    v_add_u32 v204, s20, v203
    s_lshl_b32 s20, s5, 7
    s_add_u32 s20, s20, 1792
    v_add_u32 v205, s20, v203
    v_cmp_gt_u32 vcc, 16, v202
    s_nop 1
    v_cndmask_b32 v204, v205, v204, vcc
    v_mul_u32_u24 v201, 3072, v201
    v_add_u32 v192, v201, v204
    s_lshl_b32 s20, s7, 6
    s_add_u32 s20, s20, 256
    v_add_u32 v200, s20, v1
    v_mul_u32_u24 v201, 2731, v200
    v_lshrrev_b32 v201, 16, v201
    v_mul_u32_u24 v202, 24, v201
    v_sub_u32 v202, v200, v202
    v_bfe_u32 v203, v201, 1, 1
    v_bfe_u32 v204, v201, 3, 1
    v_lshl_or_b32 v203, v204, 1, v203
    v_lshlrev_b32 v203, 1, v203
    v_xor_b32 v202, v202, v203
    v_lshlrev_b32 v203, 4, v202
    s_lshl_b32 s20, s5, 8
    v_add_u32 v204, s20, v203
    s_lshl_b32 s20, s5, 7
    s_add_u32 s20, s20, 1792
    v_add_u32 v205, s20, v203
    v_cmp_gt_u32 vcc, 16, v202
    s_nop 1
    v_cndmask_b32 v204, v205, v204, vcc
    v_mul_u32_u24 v201, 3072, v201
    v_add_u32 v193, v201, v204
    s_lshl_b32 s20, s7, 6
    s_add_u32 s20, s20, 512
    v_add_u32 v200, s20, v1
    v_mul_u32_u24 v201, 2731, v200
    v_lshrrev_b32 v201, 16, v201
    v_mul_u32_u24 v202, 24, v201
    v_sub_u32 v202, v200, v202
    v_bfe_u32 v203, v201, 1, 1
    v_bfe_u32 v204, v201, 3, 1
    v_lshl_or_b32 v203, v204, 1, v203
    v_lshlrev_b32 v203, 1, v203
    v_xor_b32 v202, v202, v203
    v_lshlrev_b32 v203, 4, v202
    s_lshl_b32 s20, s5, 8
    v_add_u32 v204, s20, v203
    s_lshl_b32 s20, s5, 7
    s_add_u32 s20, s20, 1792
    v_add_u32 v205, s20, v203
    v_cmp_gt_u32 vcc, 16, v202
    s_nop 1
    v_cndmask_b32 v204, v205, v204, vcc
    v_mul_u32_u24 v201, 3072, v201
    v_add_u32 v194, v201, v204
    s_lshl_b32 s7, s7, 10
    s_add_u32 s7, s7, 65536
    s_lshr_b32 s32, s3, 2
    s_sub_u32 s20, s2, 0
    s_cmp_ge_u32 s20, 64
    s_cbranch_scc1 nomod_8
    v_mov_b32 v64, 0
    v_mov_b32 v65, 0
    v_mov_b32 v66, 0
    v_mov_b32 v67, 0
    v_mov_b32 v68, 0
    v_mov_b32 v69, 0
    v_mov_b32 v70, 0
    v_mov_b32 v71, 0
    s_waitcnt vmcnt(8)
    v_lshlrev_b32 v76, 16, v76
    v_mul_f32 v12, 0xbfb8aa3b, v76
    v_exp_f32 v12, v12
    s_nop 0
    v_add_f32 v12, 1.0, v12
    v_rcp_f32 v12, v12
    s_nop 0
    v_mul_f32 v76, v76, v12
    v_cvt_pk_bf16_f32 v76, v76, v76
    v_lshlrev_b32 v76, 16, v76
    v_lshlrev_b32 v77, 16, v77
    v_mul_f32 v12, 0xbfb8aa3b, v77
    v_exp_f32 v12, v12
    s_nop 0
    v_add_f32 v12, 1.0, v12
    v_rcp_f32 v12, v12
    s_nop 0
    v_mul_f32 v77, v77, v12
    v_cvt_pk_bf16_f32 v77, v77, v77
    v_lshlrev_b32 v77, 16, v77
    v_lshlrev_b32 v12, 16, v80
    v_and_b32 v13, 0xffff0000, v80
    v_fmac_f32 v64, v76, v12
    v_fmac_f32 v65, v76, v13
    v_lshlrev_b32 v12, 16, v81
    v_and_b32 v13, 0xffff0000, v81
    v_fmac_f32 v66, v76, v12
    v_fmac_f32 v67, v76, v13
    v_lshlrev_b32 v12, 16, v82
    v_and_b32 v13, 0xffff0000, v82
    v_fmac_f32 v68, v76, v12
    v_fmac_f32 v69, v76, v13
    v_lshlrev_b32 v12, 16, v83
    v_and_b32 v13, 0xffff0000, v83
    v_fmac_f32 v70, v76, v12
    v_fmac_f32 v71, v76, v13
    v_lshlrev_b32 v12, 16, v84
    v_and_b32 v13, 0xffff0000, v84
    v_fmac_f32 v64, v77, v12
    v_fmac_f32 v65, v77, v13
    v_lshlrev_b32 v12, 16, v85
    v_and_b32 v13, 0xffff0000, v85
    v_fmac_f32 v66, v77, v12
    v_fmac_f32 v67, v77, v13
    v_lshlrev_b32 v12, 16, v86
    v_and_b32 v13, 0xffff0000, v86
    v_fmac_f32 v68, v77, v12
    v_fmac_f32 v69, v77, v13
    v_lshlrev_b32 v12, 16, v87
    v_and_b32 v13, 0xffff0000, v87
    v_fmac_f32 v70, v77, v12
    v_fmac_f32 v71, v77, v13
    v_add_f32_dpp v64, v64, v64 row_ror:8 row_mask:0xf bank_mask:0xf
    v_add_f32_dpp v65, v65, v65 row_ror:8 row_mask:0xf bank_mask:0xf
    v_add_f32_dpp v66, v66, v66 row_ror:8 row_mask:0xf bank_mask:0xf
    v_add_f32_dpp v67, v67, v67 row_ror:8 row_mask:0xf bank_mask:0xf
    v_add_f32_dpp v68, v68, v68 row_ror:8 row_mask:0xf bank_mask:0xf
    v_add_f32_dpp v69, v69, v69 row_ror:8 row_mask:0xf bank_mask:0xf
    v_add_f32_dpp v70, v70, v70 row_ror:8 row_mask:0xf bank_mask:0xf
    v_add_f32_dpp v71, v71, v71 row_ror:8 row_mask:0xf bank_mask:0xf
    v_lshrrev_b32 v12, 4, v0
    v_lshlrev_b32 v12, 8, v12
    v_lshl_add_u32 v12, v72, 5, v12
    v_add_u32 v12, 155648, v12
    v_and_b32 v13, 8, v1
    v_cmp_eq_u32 vcc, 0, v13
    s_nop 3
    s_and_saveexec_b64 s[44:45], vcc
    ds_write_b128 v12, v[64:67]
    ds_write_b128 v12, v[68:71] offset:16
    s_mov_b64 exec, s[44:45]
    s_waitcnt lgkmcnt(0)
    s_barrier
    s_cmp_lg_u32 s3, 7
    s_cbranch_scc1 mdone_9
    v_lshlrev_b32 v72, 2, v1
    v_add_u32 v12, 155648, v72
    ds_read_b32 v80, v12 offset:0
    ds_read_b32 v81, v12 offset:256
    ds_read_b32 v82, v12 offset:512
    ds_read_b32 v83, v12 offset:768
    ds_read_b32 v84, v12 offset:1024
    ds_read_b32 v85, v12 offset:1280
    ds_read_b32 v86, v12 offset:1536
    ds_read_b32 v87, v12 offset:1792
    ds_read_b32 v88, v12 offset:2048
    ds_read_b32 v89, v12 offset:2304
    ds_read_b32 v90, v12 offset:2560
    ds_read_b32 v91, v12 offset:2816
    ds_read_b32 v92, v12 offset:3072
    ds_read_b32 v93, v12 offset:3328
    ds_read_b32 v94, v12 offset:3584
    ds_read_b32 v95, v12 offset:3840
    ds_read_b32 v96, v12 offset:4096
    ds_read_b32 v97, v12 offset:4352
    ds_read_b32 v98, v12 offset:4608
    ds_read_b32 v99, v12 offset:4864
    ds_read_b32 v100, v12 offset:5120
    ds_read_b32 v101, v12 offset:5376
    ds_read_b32 v102, v12 offset:5632
    ds_read_b32 v103, v12 offset:5888
    ds_read_b32 v104, v12 offset:6144
    ds_read_b32 v105, v12 offset:6400
    ds_read_b32 v106, v12 offset:6656
    ds_read_b32 v107, v12 offset:6912
    ds_read_b32 v108, v12 offset:7168
    ds_read_b32 v109, v12 offset:7424
    ds_read_b32 v110, v12 offset:7680
    ds_read_b32 v111, v12 offset:7936
    s_waitcnt lgkmcnt(15)
    s_waitcnt lgkmcnt(15)
    s_waitcnt lgkmcnt(0)
    s_waitcnt lgkmcnt(0)
    v_add_f32 v80, v80, v96
    v_add_f32 v81, v81, v97
    v_add_f32 v82, v82, v98
    v_add_f32 v83, v83, v99
    v_add_f32 v84, v84, v100
    v_add_f32 v85, v85, v101
    v_add_f32 v86, v86, v102
    v_add_f32 v87, v87, v103
    v_add_f32 v88, v88, v104
    v_add_f32 v89, v89, v105
    v_add_f32 v90, v90, v106
    v_add_f32 v91, v91, v107
    v_add_f32 v92, v92, v108
    v_add_f32 v93, v93, v109
    v_add_f32 v94, v94, v110
    v_add_f32 v95, v95, v111
    v_add_f32 v80, v80, v88
    v_add_f32 v81, v81, v89
    v_add_f32 v82, v82, v90
    v_add_f32 v83, v83, v91
    v_add_f32 v84, v84, v92
    v_add_f32 v85, v85, v93
    v_add_f32 v86, v86, v94
    v_add_f32 v87, v87, v95
    v_add_f32 v80, v80, v84
    v_add_f32 v81, v81, v85
    v_add_f32 v82, v82, v86
    v_add_f32 v83, v83, v87
    v_add_f32 v80, v80, v82
    v_add_f32 v81, v81, v83
    v_add_f32 v80, v80, v81
    s_and_b32 s20, s2, 3
    s_mul_i32 s20, s20, 12288
    s_lshr_b32 s21, s2, 2
    s_lshl_b32 s21, s21, 8
    s_add_u32 s20, s20, s21
    buffer_store_dword v80, v72, s[12:15], s20 offen sc1
    s_waitcnt vmcnt(0)
    s_cmp_lg_u32 s3, 7
    s_cbranch_scc1 sig_10
    s_lshl_b32 s46, s2, 2
    s_add_u32 s46, s46, 0
    v_mov_b32 v250, s59
    v_mul_u32_u24 v251, 1024, v1
    s_mov_b64 exec, 255
    buffer_store_dword v250, v251, s[60:63], s46 offen sc1
    s_mov_b64 exec, -1
sig_10:
mdone_9:
nomod_8:
    s_mul_i32 s33, s32, 98304
    s_mul_i32 s34, s32, 12288
    s_add_u32 s34, s34, s7
    s_add_u32 s23, s33, 0
    s_add_u32 m0, s34, 0
    s_nop 0
    buffer_load_dwordx4 v192, s[16:19], s23 offen lds
    s_add_u32 m0, s34, 4096
    s_nop 0
    buffer_load_dwordx4 v193, s[16:19], s23 offen lds
    s_add_u32 m0, s34, 8192
    s_nop 0
    buffer_load_dwordx4 v194, s[16:19], s23 offen lds
    s_waitcnt vmcnt(3)
    v_lshlrev_b32 v128, 16, v32
    v_and_b32 v129, 0xffff0000, v32
    v_lshlrev_b32 v130, 16, v33
    v_and_b32 v131, 0xffff0000, v33
    v_lshlrev_b32 v132, 16, v34
    v_and_b32 v133, 0xffff0000, v34
    v_lshlrev_b32 v134, 16, v35
    v_and_b32 v135, 0xffff0000, v35
    v_lshlrev_b32 v136, 16, v36
    v_and_b32 v137, 0xffff0000, v36
    v_lshlrev_b32 v138, 16, v37
    v_and_b32 v139, 0xffff0000, v37
    v_lshlrev_b32 v140, 16, v38
    v_and_b32 v141, 0xffff0000, v38
    v_lshlrev_b32 v142, 16, v39
    v_and_b32 v143, 0xffff0000, v39
    v_lshlrev_b32 v144, 16, v40
    v_and_b32 v145, 0xffff0000, v40
    v_lshlrev_b32 v146, 16, v41
    v_and_b32 v147, 0xffff0000, v41
    v_lshlrev_b32 v148, 16, v42
    v_and_b32 v149, 0xffff0000, v42
    v_lshlrev_b32 v150, 16, v43
    v_and_b32 v151, 0xffff0000, v43
    v_lshlrev_b32 v152, 16, v44
    v_and_b32 v153, 0xffff0000, v44
    v_lshlrev_b32 v154, 16, v45
    v_and_b32 v155, 0xffff0000, v45
    v_lshlrev_b32 v156, 16, v46
    v_and_b32 v157, 0xffff0000, v46
    v_lshlrev_b32 v158, 16, v47
    v_and_b32 v159, 0xffff0000, v47
    v_lshlrev_b32 v160, 16, v48
    v_and_b32 v161, 0xffff0000, v48
    v_lshlrev_b32 v162, 16, v49
    v_and_b32 v163, 0xffff0000, v49
    v_lshlrev_b32 v164, 16, v50
    v_and_b32 v165, 0xffff0000, v50
    v_lshlrev_b32 v166, 16, v51
    v_and_b32 v167, 0xffff0000, v51
    v_lshlrev_b32 v168, 16, v52
    v_and_b32 v169, 0xffff0000, v52
    v_lshlrev_b32 v170, 16, v53
    v_and_b32 v171, 0xffff0000, v53
    v_lshlrev_b32 v172, 16, v54
    v_and_b32 v173, 0xffff0000, v54
    v_lshlrev_b32 v174, 16, v55
    v_and_b32 v175, 0xffff0000, v55
    v_lshlrev_b32 v176, 16, v56
    v_and_b32 v177, 0xffff0000, v56
    v_lshlrev_b32 v178, 16, v57
    v_and_b32 v179, 0xffff0000, v57
    v_lshlrev_b32 v180, 16, v58
    v_and_b32 v181, 0xffff0000, v58
    v_lshlrev_b32 v182, 16, v59
    v_and_b32 v183, 0xffff0000, v59
    v_lshlrev_b32 v184, 16, v60
    v_and_b32 v185, 0xffff0000, v60
    v_lshlrev_b32 v186, 16, v61
    v_and_b32 v187, 0xffff0000, v61
    v_lshlrev_b32 v188, 16, v62
    v_and_b32 v189, 0xffff0000, v62
    v_lshlrev_b32 v190, 16, v63
    v_and_b32 v191, 0xffff0000, v63
    v_pk_add_f32 v[8:9], v[128:129], v[130:131]
    v_pk_add_f32 v[10:11], v[132:133], v[134:135]
    v_pk_add_f32 v[12:13], v[136:137], v[138:139]
    v_pk_add_f32 v[14:15], v[140:141], v[142:143]
    v_pk_add_f32 v[16:17], v[160:161], v[162:163]
    v_pk_add_f32 v[18:19], v[164:165], v[166:167]
    v_pk_add_f32 v[20:21], v[168:169], v[170:171]
    v_pk_add_f32 v[22:23], v[172:173], v[174:175]
    v_pk_add_f32 v[8:9], v[8:9], v[144:145]
    v_pk_add_f32 v[16:17], v[16:17], v[176:177]
    v_pk_add_f32 v[10:11], v[10:11], v[146:147]
    v_pk_add_f32 v[18:19], v[18:19], v[178:179]
    v_pk_add_f32 v[12:13], v[12:13], v[148:149]
    v_pk_add_f32 v[20:21], v[20:21], v[180:181]
    v_pk_add_f32 v[14:15], v[14:15], v[150:151]
    v_pk_add_f32 v[22:23], v[22:23], v[182:183]
    v_pk_add_f32 v[8:9], v[8:9], v[152:153]
    v_pk_add_f32 v[16:17], v[16:17], v[184:185]
    v_pk_add_f32 v[10:11], v[10:11], v[154:155]
    v_pk_add_f32 v[18:19], v[18:19], v[186:187]
    v_pk_add_f32 v[12:13], v[12:13], v[156:157]
    v_pk_add_f32 v[20:21], v[20:21], v[188:189]
    v_pk_add_f32 v[14:15], v[14:15], v[158:159]
    v_pk_add_f32 v[22:23], v[22:23], v[190:191]
    s_add_u32 s23, s33, 196608
    s_add_u32 m0, s34, 24576
    s_nop 0
    buffer_load_dwordx4 v192, s[16:19], s23 offen lds
    s_add_u32 m0, s34, 28672
    s_nop 0
    buffer_load_dwordx4 v193, s[16:19], s23 offen lds
    s_add_u32 m0, s34, 32768
    s_nop 0
    buffer_load_dwordx4 v194, s[16:19], s23 offen lds
    v_pk_add_f32 v[8:9], v[8:9], v[10:11]
    v_pk_add_f32 v[12:13], v[12:13], v[14:15]
    v_pk_add_f32 v[16:17], v[16:17], v[18:19]
    v_pk_add_f32 v[20:21], v[20:21], v[22:23]
    v_pk_add_f32 v[8:9], v[8:9], v[12:13]
    v_pk_add_f32 v[16:17], v[16:17], v[20:21]
    v_add_f32 v24, v8, v9
    v_add_f32 v26, v16, v17
    s_nop 0
    v_add_f32_dpp v24, v24, v24 quad_perm:[1,0,3,2] row_mask:0xf bank_mask:0xf
    v_add_f32_dpp v26, v26, v26 quad_perm:[1,0,3,2] row_mask:0xf bank_mask:0xf
    s_nop 0
    v_add_f32_dpp v24, v24, v24 quad_perm:[2,3,0,1] row_mask:0xf bank_mask:0xf
    v_add_f32_dpp v26, v26, v26 quad_perm:[2,3,0,1] row_mask:0xf bank_mask:0xf
    s_nop 0
    v_add_f32_dpp v24, v24, v24 row_half_mirror row_mask:0xf bank_mask:0xf
    v_add_f32_dpp v26, v26, v26 row_half_mirror row_mask:0xf bank_mask:0xf
    s_nop 0
    v_add_f32_dpp v24, v24, v24 row_mirror row_mask:0xf bank_mask:0xf
    v_add_f32_dpp v26, v26, v26 row_mirror row_mask:0xf bank_mask:0xf
    v_mul_f32 v24, 0xbb000000, v24
    v_mov_b32 v25, v24
    v_mov_b32 v8, 0
    v_mov_b32 v9, 0
    v_mov_b32 v10, 0
    v_mov_b32 v11, 0
    v_mov_b32 v12, 0
    v_mov_b32 v13, 0
    v_mov_b32 v14, 0
    v_mov_b32 v15, 0
    v_mul_f32 v26, 0xbb000000, v26
    v_mov_b32 v27, v26
    v_mov_b32 v16, 0
    v_mov_b32 v17, 0
    v_mov_b32 v18, 0
    v_mov_b32 v19, 0
    v_mov_b32 v20, 0
    v_mov_b32 v21, 0
    v_mov_b32 v22, 0
    v_mov_b32 v23, 0
    v_pk_add_f32 v[128:129], v[128:129], v[24:25]
    v_pk_add_f32 v[160:161], v[160:161], v[26:27]
    v_pk_add_f32 v[130:131], v[130:131], v[24:25]
    v_pk_add_f32 v[162:163], v[162:163], v[26:27]
    v_pk_fma_f32 v[8:9], v[128:129], v[128:129], v[8:9]
    v_pk_fma_f32 v[16:17], v[160:161], v[160:161], v[16:17]
    v_pk_add_f32 v[132:133], v[132:133], v[24:25]
    v_pk_add_f32 v[164:165], v[164:165], v[26:27]
    v_pk_fma_f32 v[10:11], v[130:131], v[130:131], v[10:11]
    v_pk_fma_f32 v[18:19], v[162:163], v[162:163], v[18:19]
    v_pk_add_f32 v[134:135], v[134:135], v[24:25]
    v_pk_add_f32 v[166:167], v[166:167], v[26:27]
    v_pk_fma_f32 v[12:13], v[132:133], v[132:133], v[12:13]
    v_pk_fma_f32 v[20:21], v[164:165], v[164:165], v[20:21]
    v_pk_add_f32 v[136:137], v[136:137], v[24:25]
    v_pk_add_f32 v[168:169], v[168:169], v[26:27]
    v_pk_fma_f32 v[14:15], v[134:135], v[134:135], v[14:15]
    v_pk_fma_f32 v[22:23], v[166:167], v[166:167], v[22:23]
    v_pk_add_f32 v[138:139], v[138:139], v[24:25]
    v_pk_add_f32 v[170:171], v[170:171], v[26:27]
    v_pk_fma_f32 v[8:9], v[136:137], v[136:137], v[8:9]
    v_pk_fma_f32 v[16:17], v[168:169], v[168:169], v[16:17]
    v_pk_add_f32 v[140:141], v[140:141], v[24:25]
    v_pk_add_f32 v[172:173], v[172:173], v[26:27]
    v_pk_fma_f32 v[10:11], v[138:139], v[138:139], v[10:11]
    v_pk_fma_f32 v[18:19], v[170:171], v[170:171], v[18:19]
    v_pk_add_f32 v[142:143], v[142:143], v[24:25]
    v_pk_add_f32 v[174:175], v[174:175], v[26:27]
    v_pk_fma_f32 v[12:13], v[140:141], v[140:141], v[12:13]
    v_pk_fma_f32 v[20:21], v[172:173], v[172:173], v[20:21]
    s_add_u32 s23, s33, 393216
    s_add_u32 m0, s34, 49152
    s_nop 0
    buffer_load_dwordx4 v192, s[16:19], s23 offen lds
    s_add_u32 m0, s34, 53248
    s_nop 0
    buffer_load_dwordx4 v193, s[16:19], s23 offen lds
    s_add_u32 m0, s34, 57344
    s_nop 0
    buffer_load_dwordx4 v194, s[16:19], s23 offen lds
    v_pk_add_f32 v[144:145], v[144:145], v[24:25]
    v_pk_add_f32 v[176:177], v[176:177], v[26:27]
    v_pk_fma_f32 v[14:15], v[142:143], v[142:143], v[14:15]
    v_pk_fma_f32 v[22:23], v[174:175], v[174:175], v[22:23]
    v_pk_add_f32 v[146:147], v[146:147], v[24:25]
    v_pk_add_f32 v[178:179], v[178:179], v[26:27]
    v_pk_fma_f32 v[8:9], v[144:145], v[144:145], v[8:9]
    v_pk_fma_f32 v[16:17], v[176:177], v[176:177], v[16:17]
    v_pk_add_f32 v[148:149], v[148:149], v[24:25]
    v_pk_add_f32 v[180:181], v[180:181], v[26:27]
    v_pk_fma_f32 v[10:11], v[146:147], v[146:147], v[10:11]
    v_pk_fma_f32 v[18:19], v[178:179], v[178:179], v[18:19]
    v_pk_add_f32 v[150:151], v[150:151], v[24:25]
    v_pk_add_f32 v[182:183], v[182:183], v[26:27]
    v_pk_fma_f32 v[12:13], v[148:149], v[148:149], v[12:13]
    v_pk_fma_f32 v[20:21], v[180:181], v[180:181], v[20:21]
    v_pk_add_f32 v[152:153], v[152:153], v[24:25]
    v_pk_add_f32 v[184:185], v[184:185], v[26:27]
    v_pk_fma_f32 v[14:15], v[150:151], v[150:151], v[14:15]
    v_pk_fma_f32 v[22:23], v[182:183], v[182:183], v[22:23]
    v_pk_add_f32 v[154:155], v[154:155], v[24:25]
    v_pk_add_f32 v[186:187], v[186:187], v[26:27]
    v_pk_fma_f32 v[8:9], v[152:153], v[152:153], v[8:9]
    v_pk_fma_f32 v[16:17], v[184:185], v[184:185], v[16:17]
    v_pk_add_f32 v[156:157], v[156:157], v[24:25]
    v_pk_add_f32 v[188:189], v[188:189], v[26:27]
    v_pk_fma_f32 v[10:11], v[154:155], v[154:155], v[10:11]
    v_pk_fma_f32 v[18:19], v[186:187], v[186:187], v[18:19]
    v_pk_add_f32 v[158:159], v[158:159], v[24:25]
    v_pk_add_f32 v[190:191], v[190:191], v[26:27]
    v_pk_fma_f32 v[12:13], v[156:157], v[156:157], v[12:13]
    v_pk_fma_f32 v[20:21], v[188:189], v[188:189], v[20:21]
    v_pk_fma_f32 v[14:15], v[158:159], v[158:159], v[14:15]
    v_pk_fma_f32 v[22:23], v[190:191], v[190:191], v[22:23]
    v_pk_add_f32 v[8:9], v[8:9], v[10:11]
    v_pk_add_f32 v[12:13], v[12:13], v[14:15]
    v_pk_add_f32 v[16:17], v[16:17], v[18:19]
    v_pk_add_f32 v[20:21], v[20:21], v[22:23]
    v_pk_add_f32 v[8:9], v[8:9], v[12:13]
    v_pk_add_f32 v[16:17], v[16:17], v[20:21]
    v_add_f32 v24, v8, v9
    v_add_f32 v25, v16, v17
    s_nop 0
    v_add_f32_dpp v24, v24, v24 quad_perm:[1,0,3,2] row_mask:0xf bank_mask:0xf
    v_add_f32_dpp v25, v25, v25 quad_perm:[1,0,3,2] row_mask:0xf bank_mask:0xf
    s_nop 0
    v_add_f32_dpp v24, v24, v24 quad_perm:[2,3,0,1] row_mask:0xf bank_mask:0xf
    v_add_f32_dpp v25, v25, v25 quad_perm:[2,3,0,1] row_mask:0xf bank_mask:0xf
    s_nop 0
    v_add_f32_dpp v24, v24, v24 row_half_mirror row_mask:0xf bank_mask:0xf
    v_add_f32_dpp v25, v25, v25 row_half_mirror row_mask:0xf bank_mask:0xf
    s_nop 0
    v_add_f32_dpp v24, v24, v24 row_mirror row_mask:0xf bank_mask:0xf
    v_add_f32_dpp v25, v25, v25 row_mirror row_mask:0xf bank_mask:0xf
    v_mov_b32 v14, 0x3727c5ac
    v_fmac_f32 v14, 0x3b000000, v24
    v_rsq_f32 v20, v14
    v_mov_b32 v14, 0x3727c5ac
    v_fmac_f32 v14, 0x3b000000, v25
    v_rsq_f32 v22, v14
    v_mov_b32 v21, v20
    v_mov_b32 v23, v22
    v_pk_mul_f32 v[128:129], v[128:129], v[20:21]
    v_pk_mul_f32 v[130:131], v[130:131], v[20:21]
    v_pk_mul_f32 v[132:133], v[132:133], v[20:21]
    v_pk_mul_f32 v[134:135], v[134:135], v[20:21]
    v_pk_mul_f32 v[136:137], v[136:137], v[20:21]
    v_pk_mul_f32 v[138:139], v[138:139], v[20:21]
    v_pk_mul_f32 v[140:141], v[140:141], v[20:21]
    v_pk_mul_f32 v[142:143], v[142:143], v[20:21]
    v_pk_mul_f32 v[144:145], v[144:145], v[20:21]
    v_pk_mul_f32 v[146:147], v[146:147], v[20:21]
    v_pk_mul_f32 v[148:149], v[148:149], v[20:21]
    v_pk_mul_f32 v[150:151], v[150:151], v[20:21]
    v_pk_mul_f32 v[152:153], v[152:153], v[20:21]
    v_pk_mul_f32 v[154:155], v[154:155], v[20:21]
    v_pk_mul_f32 v[156:157], v[156:157], v[20:21]
    v_pk_mul_f32 v[158:159], v[158:159], v[20:21]
    v_pk_mul_f32 v[160:161], v[160:161], v[22:23]
    v_pk_mul_f32 v[162:163], v[162:163], v[22:23]
    v_pk_mul_f32 v[164:165], v[164:165], v[22:23]
    v_pk_mul_f32 v[166:167], v[166:167], v[22:23]
    v_pk_mul_f32 v[168:169], v[168:169], v[22:23]
    v_pk_mul_f32 v[170:171], v[170:171], v[22:23]
    v_pk_mul_f32 v[172:173], v[172:173], v[22:23]
    v_pk_mul_f32 v[174:175], v[174:175], v[22:23]
    v_pk_mul_f32 v[176:177], v[176:177], v[22:23]
    v_pk_mul_f32 v[178:179], v[178:179], v[22:23]
    v_pk_mul_f32 v[180:181], v[180:181], v[22:23]
    v_pk_mul_f32 v[182:183], v[182:183], v[22:23]
    v_pk_mul_f32 v[184:185], v[184:185], v[22:23]
    v_pk_mul_f32 v[186:187], v[186:187], v[22:23]
    v_pk_mul_f32 v[188:189], v[188:189], v[22:23]
    v_pk_mul_f32 v[190:191], v[190:191], v[22:23]
    s_cmp_eq_u32 s3, 7
    s_cbranch_scc1 wf7_12
    s_branch wf_11
wf7_12:
    s_and_b32 s46, s2, 7
    s_lshl_b32 s46, s46, 10
    s_add_u32 s46, s46, 0
    v_lshlrev_b32 v251, 2, v1
    s_mov_b32 s42, 0xffffffff
    s_mov_b32 s43, 0xffffffff
    s_mov_b32 s47, 0
poll_13:
    buffer_load_dword v250, v251, s[60:63], s46 offen sc0 sc1
    s_add_u32 s47, s47, 1
    s_cmp_gt_u32 s47, 1048576
    s_cbranch_scc1 polled_14
    s_waitcnt vmcnt(0)
    v_cmp_eq_u32 vcc, s59, v250
    s_nop 3
    s_and_b64 vcc, vcc, s[42:43]
    s_cmp_eq_u64 vcc, s[42:43]
    s_cbranch_scc0 poll_13
polled_14:
wf_11:
    s_barrier
    v_lshlrev_b32 v248, 3, v0
    s_mov_b32 s22, 0
    buffer_load_dwordx2 v[240:241], v248, s[12:15], s22 offen
    s_mov_b32 s22, 12288
    buffer_load_dwordx2 v[242:243], v248, s[12:15], s22 offen
    s_mov_b32 s22, 24576
    buffer_load_dwordx2 v[244:245], v248, s[12:15], s22 offen
    s_mov_b32 s22, 36864
    buffer_load_dwordx2 v[246:247], v248, s[12:15], s22 offen
    v_mov_b32 v249, 0
    ds_read_b32 v249, v249
    s_waitcnt lgkmcnt(0)
    v_readfirstlane_b32 s59, v249
    v_lshrrev_b32 v3, 4, v1
    v_and_b32 v4, 15, v1
    v_lshrrev_b32 v5, 2, v4
    v_and_b32 v6, 3, v4
    v_lshl_add_u32 v7, v3, 3, v5
    v_mul_u32_u24 v7, 384, v7
    v_lshl_add_u32 v7, v6, 3, v7
    v_add_u32 v7, 65536, v7
    v_bfe_u32 v8, v5, 1, 1
    v_and_b32 v9, 1, v3
    v_lshl_or_b32 v8, v9, 1, v8
    s_lshr_b32 s20, s3, 1
    s_lshl_b32 s21, s20, 1
    s_add_u32 s21, s21, 0
    s_lshr_b32 s22, s21, 2
    s_lshl_b32 s22, s22, 7
    s_and_b32 s21, s21, 3
    v_xor_b32 v9, s21, v8
    v_lshl_add_u32 v200, v9, 5, v7
    v_add_u32 v200, s22, v200
    v_add_u32 v204, 61440, v200
    s_lshl_b32 s21, s20, 1
    s_add_u32 s21, s21, 1
    s_lshr_b32 s22, s21, 2
    s_lshl_b32 s22, s22, 7
    s_and_b32 s21, s21, 3
    v_xor_b32 v9, s21, v8
    v_lshl_add_u32 v201, v9, 5, v7
    v_add_u32 v201, s22, v201
    v_add_u32 v205, 61440, v201
    s_add_u32 s21, s20, 8
    s_lshr_b32 s22, s21, 2
    s_lshl_b32 s22, s22, 7
    s_and_b32 s21, s21, 3
    v_xor_b32 v9, s21, v8
    v_lshl_add_u32 v202, v9, 5, v7
    v_add_u32 v202, s22, v202
    v_add_u32 v206, 61440, v202
    s_and_b32 s21, s3, 1
    s_lshl_b32 s21, s21, 5
    v_add_u32 v9, s21, v4
    v_lshlrev_b32 v9, 10, v9
    v_add_u32 v10, 0, v3
    v_xor_b32 v10, v10, v4
    v_lshl_add_u32 v208, v10, 4, v9
    v_add_u32 v10, 4, v3
    v_xor_b32 v10, v10, v4
    v_lshl_add_u32 v209, v10, 4, v9
    v_add_u32 v10, 8, v3
    v_xor_b32 v10, v10, v4
    v_lshl_add_u32 v210, v10, 4, v9
    v_add_u32 v10, 12, v3
    v_xor_b32 v10, v10, v4
    v_lshl_add_u32 v211, v10, 4, v9
    s_waitcnt vmcnt(0)
    v_pk_add_f32 v[240:241], v[240:241], v[242:243]
    v_pk_add_f32 v[244:245], v[244:245], v[246:247]
    v_pk_add_f32 v[240:241], v[240:241], v[244:245]
    v_cvt_pk_bf16_f32 v242, v240, v241
    v_lshlrev_b32 v240, 16, v242
    v_and_b32 v241, 0xffff0000, v242
    s_cmp_lt_u32 s3, 4
    s_cbranch_scc1 mf_15
    v_add_f32 v240, 1.0, v240
    v_add_f32 v241, 1.0, v241
    v_cvt_pk_bf16_f32 v242, v240, v241
    v_lshlrev_b32 v240, 16, v242
    v_and_b32 v241, 0xffff0000, v242
mf_15:
    v_and_b32 v242, 255, v0
    v_lshlrev_b32 v242, 1, v242
    v_lshrrev_b32 v243, 7, v242
    v_lshlrev_b32 v248, 9, v243
    v_bfe_u32 v243, v242, 2, 1
    v_lshl_add_u32 v248, v243, 8, v248
    v_bfe_u32 v243, v242, 3, 4
    v_lshl_add_u32 v248, v243, 4, v248
    v_and_b32 v243, 3, v242
    v_lshl_add_u32 v248, v243, 2, v248
    v_lshrrev_b32 v243, 8, v0
    v_lshl_add_u32 v248, v243, 11, v248
    v_add_u32 v248, 151552, v248
    ds_write_b64 v248, v[240:241]
    s_waitcnt lgkmcnt(0)
    s_barrier
    v_lshrrev_b32 v3, 4, v1
    v_and_b32 v4, 15, v1
    v_lshlrev_b32 v6, 4, v4
    v_add_u32 v6, 151552, v6
    ds_read_b128 v[64:67], v6 offset:2048
    ds_read_b128 v[96:99], v6 offset:0
    ds_read_b128 v[68:71], v6 offset:2304
    ds_read_b128 v[100:103], v6 offset:256
    ds_read_b128 v[72:75], v6 offset:2560
    ds_read_b128 v[104:107], v6 offset:512
    ds_read_b128 v[76:79], v6 offset:2816
    ds_read_b128 v[108:111], v6 offset:768
    ds_read_b128 v[80:83], v6 offset:3072
    ds_read_b128 v[112:115], v6 offset:1024
    ds_read_b128 v[84:87], v6 offset:3328
    ds_read_b128 v[116:119], v6 offset:1280
    ds_read_b128 v[88:91], v6 offset:3584
    ds_read_b128 v[120:123], v6 offset:1536
    ds_read_b128 v[92:95], v6 offset:3840
    ds_read_b128 v[124:127], v6 offset:1792
    s_lshl_b32 s20, s3, 3
    s_add_u32 s20, s20, 0
    v_add_u32 v15, s20, v3
    v_and_b32 v16, 15, v15
    v_xor_b32 v16, v16, v4
    v_lshlrev_b32 v15, 10, v15
    v_lshl_add_u32 v18, v16, 4, v15
    s_lshl_b32 s20, s3, 3
    s_add_u32 s20, s20, 4
    v_add_u32 v15, s20, v3
    v_and_b32 v16, 15, v15
    v_xor_b32 v16, v16, v4
    v_lshlrev_b32 v15, 10, v15
    v_lshl_add_u32 v19, v16, 4, v15
    s_waitcnt lgkmcnt(12)
    v_pk_fma_f32 v[128:129], v[128:129], v[64:65], v[96:97]
    v_pk_fma_f32 v[130:131], v[130:131], v[66:67], v[98:99]
    v_pk_fma_f32 v[132:133], v[132:133], v[68:69], v[100:101]
    v_pk_fma_f32 v[134:135], v[134:135], v[70:71], v[102:103]
    v_cvt_pk_bf16_f32 v24, v128, v129
    v_cvt_pk_bf16_f32 v25, v130, v131
    v_cvt_pk_bf16_f32 v26, v132, v133
    v_cvt_pk_bf16_f32 v27, v134, v135
    ds_write_b128 v18, v[24:27] offset:0
    v_pk_fma_f32 v[160:161], v[160:161], v[64:65], v[96:97]
    v_pk_fma_f32 v[162:163], v[162:163], v[66:67], v[98:99]
    v_pk_fma_f32 v[164:165], v[164:165], v[68:69], v[100:101]
    v_pk_fma_f32 v[166:167], v[166:167], v[70:71], v[102:103]
    v_cvt_pk_bf16_f32 v28, v160, v161
    v_cvt_pk_bf16_f32 v29, v162, v163
    v_cvt_pk_bf16_f32 v30, v164, v165
    v_cvt_pk_bf16_f32 v31, v166, v167
    ds_write_b128 v19, v[28:31] offset:0
    s_waitcnt lgkmcnt(0)
    v_pk_fma_f32 v[136:137], v[136:137], v[72:73], v[104:105]
    v_pk_fma_f32 v[138:139], v[138:139], v[74:75], v[106:107]
    v_pk_fma_f32 v[140:141], v[140:141], v[76:77], v[108:109]
    v_pk_fma_f32 v[142:143], v[142:143], v[78:79], v[110:111]
    v_cvt_pk_bf16_f32 v24, v136, v137
    v_cvt_pk_bf16_f32 v25, v138, v139
    v_cvt_pk_bf16_f32 v26, v140, v141
    v_cvt_pk_bf16_f32 v27, v142, v143
    ds_write_b128 v18, v[24:27] offset:256
    v_pk_fma_f32 v[168:169], v[168:169], v[72:73], v[104:105]
    v_pk_fma_f32 v[170:171], v[170:171], v[74:75], v[106:107]
    v_pk_fma_f32 v[172:173], v[172:173], v[76:77], v[108:109]
    v_pk_fma_f32 v[174:175], v[174:175], v[78:79], v[110:111]
    v_cvt_pk_bf16_f32 v28, v168, v169
    v_cvt_pk_bf16_f32 v29, v170, v171
    v_cvt_pk_bf16_f32 v30, v172, v173
    v_cvt_pk_bf16_f32 v31, v174, v175
    ds_write_b128 v19, v[28:31] offset:256
    s_nop 0
    v_pk_fma_f32 v[144:145], v[144:145], v[80:81], v[112:113]
    v_pk_fma_f32 v[146:147], v[146:147], v[82:83], v[114:115]
    v_pk_fma_f32 v[148:149], v[148:149], v[84:85], v[116:117]
    v_pk_fma_f32 v[150:151], v[150:151], v[86:87], v[118:119]
    v_cvt_pk_bf16_f32 v24, v144, v145
    v_cvt_pk_bf16_f32 v25, v146, v147
    v_cvt_pk_bf16_f32 v26, v148, v149
    v_cvt_pk_bf16_f32 v27, v150, v151
    ds_write_b128 v18, v[24:27] offset:512
    v_pk_fma_f32 v[176:177], v[176:177], v[80:81], v[112:113]
    v_pk_fma_f32 v[178:179], v[178:179], v[82:83], v[114:115]
    v_pk_fma_f32 v[180:181], v[180:181], v[84:85], v[116:117]
    v_pk_fma_f32 v[182:183], v[182:183], v[86:87], v[118:119]
    v_cvt_pk_bf16_f32 v28, v176, v177
    v_cvt_pk_bf16_f32 v29, v178, v179
    v_cvt_pk_bf16_f32 v30, v180, v181
    v_cvt_pk_bf16_f32 v31, v182, v183
    ds_write_b128 v19, v[28:31] offset:512
    s_nop 0
    v_pk_fma_f32 v[152:153], v[152:153], v[88:89], v[120:121]
    v_pk_fma_f32 v[154:155], v[154:155], v[90:91], v[122:123]
    v_pk_fma_f32 v[156:157], v[156:157], v[92:93], v[124:125]
    v_pk_fma_f32 v[158:159], v[158:159], v[94:95], v[126:127]
    v_cvt_pk_bf16_f32 v24, v152, v153
    v_cvt_pk_bf16_f32 v25, v154, v155
    v_cvt_pk_bf16_f32 v26, v156, v157
    v_cvt_pk_bf16_f32 v27, v158, v159
    ds_write_b128 v18, v[24:27] offset:768
    v_pk_fma_f32 v[184:185], v[184:185], v[88:89], v[120:121]
    v_pk_fma_f32 v[186:187], v[186:187], v[90:91], v[122:123]
    v_pk_fma_f32 v[188:189], v[188:189], v[92:93], v[124:125]
    v_pk_fma_f32 v[190:191], v[190:191], v[94:95], v[126:127]
    v_cvt_pk_bf16_f32 v28, v184, v185
    v_cvt_pk_bf16_f32 v29, v186, v187
    v_cvt_pk_bf16_f32 v30, v188, v189
    v_cvt_pk_bf16_f32 v31, v190, v191
    ds_write_b128 v19, v[28:31] offset:768
    s_waitcnt lgkmcnt(0)
    s_barrier
    v_mov_b32 v212, 0
    v_mov_b32 v213, 0
    v_mov_b32 v214, 0
    v_mov_b32 v215, 0
    v_mov_b32 v216, 0
    v_mov_b32 v217, 0
    v_mov_b32 v218, 0
    v_mov_b32 v219, 0
    v_mov_b32 v220, 0
    v_mov_b32 v221, 0
    v_mov_b32 v222, 0
    v_mov_b32 v223, 0
    v_mov_b32 v224, 0
    v_mov_b32 v225, 0
    v_mov_b32 v226, 0
    v_mov_b32 v227, 0
    v_mov_b32 v228, 0
    v_mov_b32 v229, 0
    v_mov_b32 v230, 0
    v_mov_b32 v231, 0
    v_mov_b32 v232, 0
    v_mov_b32 v233, 0
    v_mov_b32 v234, 0
    v_mov_b32 v235, 0
    ds_read_b128 v[32:35], v208 offset:0
    ds_read_b128 v[36:39], v208 offset:16384
    ds_read_b64_tr_b16 v[40:41], v200 offset:0
    ds_read_b64_tr_b16 v[42:43], v200 offset:1536
    ds_read_b64_tr_b16 v[44:45], v201 offset:0
    ds_read_b64_tr_b16 v[46:47], v201 offset:1536
    ds_read_b64_tr_b16 v[48:49], v202 offset:0
    ds_read_b64_tr_b16 v[50:51], v202 offset:1536
    s_barrier
    s_waitcnt lgkmcnt(0)
    v_mfma_f32_16x16x32_bf16 v[212:215], v[40:43], v[32:35], v[212:215]
    ds_read_b128 v[64:67], v209 offset:0
    ds_read_b128 v[68:71], v209 offset:16384
    v_mfma_f32_16x16x32_bf16 v[224:227], v[40:43], v[36:39], v[224:227]
    ds_read_b64_tr_b16 v[72:73], v200 offset:12288
    ds_read_b64_tr_b16 v[74:75], v200 offset:13824
    v_mfma_f32_16x16x32_bf16 v[216:219], v[44:47], v[32:35], v[216:219]
    ds_read_b64_tr_b16 v[76:77], v201 offset:12288
    v_mfma_f32_16x16x32_bf16 v[228:231], v[44:47], v[36:39], v[228:231]
    ds_read_b64_tr_b16 v[78:79], v201 offset:13824
    v_mfma_f32_16x16x32_bf16 v[220:223], v[32:35], v[48:51], v[220:223]
    ds_read_b64_tr_b16 v[80:81], v202 offset:12288
    v_mfma_f32_16x16x32_bf16 v[232:235], v[36:39], v[48:51], v[232:235]
    ds_read_b64_tr_b16 v[82:83], v202 offset:13824
    s_cmp_lg_u32 s32, 0
    s_cbranch_scc1 qkv_sk_16
    s_mov_b32 s23, 589824
    s_add_u32 m0, s7, 73728
    s_nop 0
    buffer_load_dwordx4 v192, s[16:19], s23 offen lds
    s_add_u32 m0, s7, 77824
    s_nop 0
    buffer_load_dwordx4 v193, s[16:19], s23 offen lds
    s_add_u32 m0, s7, 81920
    s_nop 0
    buffer_load_dwordx4 v194, s[16:19], s23 offen lds
qkv_sk_16:
    s_barrier
    s_waitcnt lgkmcnt(0)
    v_mfma_f32_16x16x32_bf16 v[212:215], v[72:75], v[64:67], v[212:215]
    ds_read_b128 v[32:35], v210 offset:0
    ds_read_b128 v[36:39], v210 offset:16384
    v_mfma_f32_16x16x32_bf16 v[224:227], v[72:75], v[68:71], v[224:227]
    ds_read_b64_tr_b16 v[40:41], v200 offset:24576
    ds_read_b64_tr_b16 v[42:43], v200 offset:26112
    v_mfma_f32_16x16x32_bf16 v[216:219], v[76:79], v[64:67], v[216:219]
    ds_read_b64_tr_b16 v[44:45], v201 offset:24576
    v_mfma_f32_16x16x32_bf16 v[228:231], v[76:79], v[68:71], v[228:231]
    ds_read_b64_tr_b16 v[46:47], v201 offset:26112
    v_mfma_f32_16x16x32_bf16 v[220:223], v[64:67], v[80:83], v[220:223]
    ds_read_b64_tr_b16 v[48:49], v202 offset:24576
    v_mfma_f32_16x16x32_bf16 v[232:235], v[68:71], v[80:83], v[232:235]
    ds_read_b64_tr_b16 v[50:51], v202 offset:26112
    s_cmp_lg_u32 s32, 1
    s_cbranch_scc1 qkv_sk_17
    s_mov_b32 s23, 688128
    s_add_u32 m0, s7, 0
    s_nop 0
    buffer_load_dwordx4 v192, s[16:19], s23 offen lds
    s_add_u32 m0, s7, 4096
    s_nop 0
    buffer_load_dwordx4 v193, s[16:19], s23 offen lds
    s_add_u32 m0, s7, 8192
    s_nop 0
    buffer_load_dwordx4 v194, s[16:19], s23 offen lds
qkv_sk_17:
    s_barrier
    s_waitcnt lgkmcnt(0)
    v_mfma_f32_16x16x32_bf16 v[212:215], v[40:43], v[32:35], v[212:215]
    ds_read_b128 v[64:67], v211 offset:0
    ds_read_b128 v[68:71], v211 offset:16384
    v_mfma_f32_16x16x32_bf16 v[224:227], v[40:43], v[36:39], v[224:227]
    ds_read_b64_tr_b16 v[72:73], v200 offset:36864
    ds_read_b64_tr_b16 v[74:75], v200 offset:38400
    v_mfma_f32_16x16x32_bf16 v[216:219], v[44:47], v[32:35], v[216:219]
    ds_read_b64_tr_b16 v[76:77], v201 offset:36864
    v_mfma_f32_16x16x32_bf16 v[228:231], v[44:47], v[36:39], v[228:231]
    ds_read_b64_tr_b16 v[78:79], v201 offset:38400
    v_mfma_f32_16x16x32_bf16 v[220:223], v[32:35], v[48:51], v[220:223]
    ds_read_b64_tr_b16 v[80:81], v202 offset:36864
    v_mfma_f32_16x16x32_bf16 v[232:235], v[36:39], v[48:51], v[232:235]
    ds_read_b64_tr_b16 v[82:83], v202 offset:38400
    s_cmp_lg_u32 s32, 0
    s_cbranch_scc1 qkv_sk_18
    s_mov_b32 s23, 786432
    s_add_u32 m0, s7, 12288
    s_nop 0
    buffer_load_dwordx4 v192, s[16:19], s23 offen lds
    s_add_u32 m0, s7, 16384
    s_nop 0
    buffer_load_dwordx4 v193, s[16:19], s23 offen lds
    s_add_u32 m0, s7, 20480
    s_nop 0
    buffer_load_dwordx4 v194, s[16:19], s23 offen lds
qkv_sk_18:
    s_barrier
    s_waitcnt lgkmcnt(0)
    v_mfma_f32_16x16x32_bf16 v[212:215], v[72:75], v[64:67], v[212:215]
    ds_read_b128 v[32:35], v208 offset:256
    ds_read_b128 v[36:39], v208 offset:16640
    v_mfma_f32_16x16x32_bf16 v[224:227], v[72:75], v[68:71], v[224:227]
    ds_read_b64_tr_b16 v[40:41], v200 offset:49152
    ds_read_b64_tr_b16 v[42:43], v200 offset:50688
    v_mfma_f32_16x16x32_bf16 v[216:219], v[76:79], v[64:67], v[216:219]
    ds_read_b64_tr_b16 v[44:45], v201 offset:49152
    v_mfma_f32_16x16x32_bf16 v[228:231], v[76:79], v[68:71], v[228:231]
    ds_read_b64_tr_b16 v[46:47], v201 offset:50688
    v_mfma_f32_16x16x32_bf16 v[220:223], v[64:67], v[80:83], v[220:223]
    ds_read_b64_tr_b16 v[48:49], v202 offset:49152
    v_mfma_f32_16x16x32_bf16 v[232:235], v[68:71], v[80:83], v[232:235]
    ds_read_b64_tr_b16 v[50:51], v202 offset:50688
    s_cmp_lg_u32 s32, 1
    s_cbranch_scc1 qkv_sk_19
    s_mov_b32 s23, 884736
    s_add_u32 m0, s7, 24576
    s_nop 0
    buffer_load_dwordx4 v192, s[16:19], s23 offen lds
    s_add_u32 m0, s7, 28672
    s_nop 0
    buffer_load_dwordx4 v193, s[16:19], s23 offen lds
    s_add_u32 m0, s7, 32768
    s_nop 0
    buffer_load_dwordx4 v194, s[16:19], s23 offen lds
qkv_sk_19:
    s_barrier
    s_waitcnt lgkmcnt(0)
    v_mfma_f32_16x16x32_bf16 v[212:215], v[40:43], v[32:35], v[212:215]
    ds_read_b128 v[64:67], v209 offset:256
    ds_read_b128 v[68:71], v209 offset:16640
    v_mfma_f32_16x16x32_bf16 v[224:227], v[40:43], v[36:39], v[224:227]
    ds_read_b64_tr_b16 v[72:73], v204 offset:0
    ds_read_b64_tr_b16 v[74:75], v204 offset:1536
    v_mfma_f32_16x16x32_bf16 v[216:219], v[44:47], v[32:35], v[216:219]
    ds_read_b64_tr_b16 v[76:77], v205 offset:0
    v_mfma_f32_16x16x32_bf16 v[228:231], v[44:47], v[36:39], v[228:231]
    ds_read_b64_tr_b16 v[78:79], v205 offset:1536
    v_mfma_f32_16x16x32_bf16 v[220:223], v[32:35], v[48:51], v[220:223]
    ds_read_b64_tr_b16 v[80:81], v206 offset:0
    v_mfma_f32_16x16x32_bf16 v[232:235], v[36:39], v[48:51], v[232:235]
    ds_read_b64_tr_b16 v[82:83], v206 offset:1536
    s_cmp_lg_u32 s32, 0
    s_cbranch_scc1 qkv_sk_20
    s_mov_b32 s23, 983040
    s_add_u32 m0, s7, 36864
    s_nop 0
    buffer_load_dwordx4 v192, s[16:19], s23 offen lds
    s_add_u32 m0, s7, 40960
    s_nop 0
    buffer_load_dwordx4 v193, s[16:19], s23 offen lds
    s_add_u32 m0, s7, 45056
    s_nop 0
    buffer_load_dwordx4 v194, s[16:19], s23 offen lds
qkv_sk_20:
    s_waitcnt vmcnt(6)
    s_barrier
    s_waitcnt lgkmcnt(0)
    v_mfma_f32_16x16x32_bf16 v[212:215], v[72:75], v[64:67], v[212:215]
    ds_read_b128 v[32:35], v210 offset:256
    ds_read_b128 v[36:39], v210 offset:16640
    v_mfma_f32_16x16x32_bf16 v[224:227], v[72:75], v[68:71], v[224:227]
    ds_read_b64_tr_b16 v[40:41], v204 offset:12288
    ds_read_b64_tr_b16 v[42:43], v204 offset:13824
    v_mfma_f32_16x16x32_bf16 v[216:219], v[76:79], v[64:67], v[216:219]
    ds_read_b64_tr_b16 v[44:45], v205 offset:12288
    v_mfma_f32_16x16x32_bf16 v[228:231], v[76:79], v[68:71], v[228:231]
    ds_read_b64_tr_b16 v[46:47], v205 offset:13824
    v_mfma_f32_16x16x32_bf16 v[220:223], v[64:67], v[80:83], v[220:223]
    ds_read_b64_tr_b16 v[48:49], v206 offset:12288
    v_mfma_f32_16x16x32_bf16 v[232:235], v[68:71], v[80:83], v[232:235]
    ds_read_b64_tr_b16 v[50:51], v206 offset:13824
    s_cmp_lg_u32 s32, 1
    s_cbranch_scc1 qkv_sk_21
    s_mov_b32 s23, 1081344
    s_add_u32 m0, s7, 49152
    s_nop 0
    buffer_load_dwordx4 v192, s[16:19], s23 offen lds
    s_add_u32 m0, s7, 53248
    s_nop 0
    buffer_load_dwordx4 v193, s[16:19], s23 offen lds
    s_add_u32 m0, s7, 57344
    s_nop 0
    buffer_load_dwordx4 v194, s[16:19], s23 offen lds
qkv_sk_21:
    s_waitcnt vmcnt(6)
    s_barrier
    s_waitcnt lgkmcnt(0)
    v_mfma_f32_16x16x32_bf16 v[212:215], v[40:43], v[32:35], v[212:215]
    ds_read_b128 v[64:67], v211 offset:256
    ds_read_b128 v[68:71], v211 offset:16640
    v_mfma_f32_16x16x32_bf16 v[224:227], v[40:43], v[36:39], v[224:227]
    ds_read_b64_tr_b16 v[72:73], v200 offset:0
    ds_read_b64_tr_b16 v[74:75], v200 offset:1536
    v_mfma_f32_16x16x32_bf16 v[216:219], v[44:47], v[32:35], v[216:219]
    ds_read_b64_tr_b16 v[76:77], v201 offset:0
    v_mfma_f32_16x16x32_bf16 v[228:231], v[44:47], v[36:39], v[228:231]
    ds_read_b64_tr_b16 v[78:79], v201 offset:1536
    v_mfma_f32_16x16x32_bf16 v[220:223], v[32:35], v[48:51], v[220:223]
    ds_read_b64_tr_b16 v[80:81], v202 offset:0
    v_mfma_f32_16x16x32_bf16 v[232:235], v[36:39], v[48:51], v[232:235]
    ds_read_b64_tr_b16 v[82:83], v202 offset:1536
    s_cmp_lg_u32 s32, 0
    s_cbranch_scc1 qkv_sk_22
    s_mov_b32 s23, 1179648
    s_add_u32 m0, s7, 61440
    s_nop 0
    buffer_load_dwordx4 v192, s[16:19], s23 offen lds
    s_add_u32 m0, s7, 65536
    s_nop 0
    buffer_load_dwordx4 v193, s[16:19], s23 offen lds
    s_add_u32 m0, s7, 69632
    s_nop 0
    buffer_load_dwordx4 v194, s[16:19], s23 offen lds
qkv_sk_22:
    s_waitcnt vmcnt(6)
    s_barrier
    s_waitcnt lgkmcnt(0)
    v_mfma_f32_16x16x32_bf16 v[212:215], v[72:75], v[64:67], v[212:215]
    ds_read_b128 v[32:35], v208 offset:512
    ds_read_b128 v[36:39], v208 offset:16896
    v_mfma_f32_16x16x32_bf16 v[224:227], v[72:75], v[68:71], v[224:227]
    ds_read_b64_tr_b16 v[40:41], v200 offset:12288
    ds_read_b64_tr_b16 v[42:43], v200 offset:13824
    v_mfma_f32_16x16x32_bf16 v[216:219], v[76:79], v[64:67], v[216:219]
    ds_read_b64_tr_b16 v[44:45], v201 offset:12288
    v_mfma_f32_16x16x32_bf16 v[228:231], v[76:79], v[68:71], v[228:231]
    ds_read_b64_tr_b16 v[46:47], v201 offset:13824
    v_mfma_f32_16x16x32_bf16 v[220:223], v[64:67], v[80:83], v[220:223]
    ds_read_b64_tr_b16 v[48:49], v202 offset:12288
    v_mfma_f32_16x16x32_bf16 v[232:235], v[68:71], v[80:83], v[232:235]
    ds_read_b64_tr_b16 v[50:51], v202 offset:13824
    s_cmp_lg_u32 s32, 1
    s_cbranch_scc1 qkv_sk_23
    s_mov_b32 s23, 1277952
    s_add_u32 m0, s7, 73728
    s_nop 0
    buffer_load_dwordx4 v192, s[16:19], s23 offen lds
    s_add_u32 m0, s7, 77824
    s_nop 0
    buffer_load_dwordx4 v193, s[16:19], s23 offen lds
    s_add_u32 m0, s7, 81920
    s_nop 0
    buffer_load_dwordx4 v194, s[16:19], s23 offen lds
qkv_sk_23:
    s_waitcnt vmcnt(6)
    s_barrier
    s_waitcnt lgkmcnt(0)
    v_mfma_f32_16x16x32_bf16 v[212:215], v[40:43], v[32:35], v[212:215]
    ds_read_b128 v[64:67], v209 offset:512
    ds_read_b128 v[68:71], v209 offset:16896
    v_mfma_f32_16x16x32_bf16 v[224:227], v[40:43], v[36:39], v[224:227]
    ds_read_b64_tr_b16 v[72:73], v200 offset:24576
    ds_read_b64_tr_b16 v[74:75], v200 offset:26112
    v_mfma_f32_16x16x32_bf16 v[216:219], v[44:47], v[32:35], v[216:219]
    ds_read_b64_tr_b16 v[76:77], v201 offset:24576
    v_mfma_f32_16x16x32_bf16 v[228:231], v[44:47], v[36:39], v[228:231]
    ds_read_b64_tr_b16 v[78:79], v201 offset:26112
    v_mfma_f32_16x16x32_bf16 v[220:223], v[32:35], v[48:51], v[220:223]
    ds_read_b64_tr_b16 v[80:81], v202 offset:24576
    v_mfma_f32_16x16x32_bf16 v[232:235], v[36:39], v[48:51], v[232:235]
    ds_read_b64_tr_b16 v[82:83], v202 offset:26112
    s_cmp_lg_u32 s32, 0
    s_cbranch_scc1 qkv_sk_24
    s_mov_b32 s23, 1376256
    s_add_u32 m0, s7, 0
    s_nop 0
    buffer_load_dwordx4 v192, s[16:19], s23 offen lds
    s_add_u32 m0, s7, 4096
    s_nop 0
    buffer_load_dwordx4 v193, s[16:19], s23 offen lds
    s_add_u32 m0, s7, 8192
    s_nop 0
    buffer_load_dwordx4 v194, s[16:19], s23 offen lds
qkv_sk_24:
    s_waitcnt vmcnt(6)
    s_barrier
    s_waitcnt lgkmcnt(0)
    v_mfma_f32_16x16x32_bf16 v[212:215], v[72:75], v[64:67], v[212:215]
    ds_read_b128 v[32:35], v210 offset:512
    ds_read_b128 v[36:39], v210 offset:16896
    v_mfma_f32_16x16x32_bf16 v[224:227], v[72:75], v[68:71], v[224:227]
    ds_read_b64_tr_b16 v[40:41], v200 offset:36864
    ds_read_b64_tr_b16 v[42:43], v200 offset:38400
    v_mfma_f32_16x16x32_bf16 v[216:219], v[76:79], v[64:67], v[216:219]
    ds_read_b64_tr_b16 v[44:45], v201 offset:36864
    v_mfma_f32_16x16x32_bf16 v[228:231], v[76:79], v[68:71], v[228:231]
    ds_read_b64_tr_b16 v[46:47], v201 offset:38400
    v_mfma_f32_16x16x32_bf16 v[220:223], v[64:67], v[80:83], v[220:223]
    ds_read_b64_tr_b16 v[48:49], v202 offset:36864
    v_mfma_f32_16x16x32_bf16 v[232:235], v[68:71], v[80:83], v[232:235]
    ds_read_b64_tr_b16 v[50:51], v202 offset:38400
    s_cmp_lg_u32 s32, 1
    s_cbranch_scc1 qkv_sk_25
    s_mov_b32 s23, 1474560
    s_add_u32 m0, s7, 12288
    s_nop 0
    buffer_load_dwordx4 v192, s[16:19], s23 offen lds
    s_add_u32 m0, s7, 16384
    s_nop 0
    buffer_load_dwordx4 v193, s[16:19], s23 offen lds
    s_add_u32 m0, s7, 20480
    s_nop 0
    buffer_load_dwordx4 v194, s[16:19], s23 offen lds
qkv_sk_25:
    s_waitcnt vmcnt(6)
    s_barrier
    s_waitcnt lgkmcnt(0)
    v_mfma_f32_16x16x32_bf16 v[212:215], v[40:43], v[32:35], v[212:215]
    ds_read_b128 v[64:67], v211 offset:512
    ds_read_b128 v[68:71], v211 offset:16896
    v_mfma_f32_16x16x32_bf16 v[224:227], v[40:43], v[36:39], v[224:227]
    ds_read_b64_tr_b16 v[72:73], v200 offset:49152
    ds_read_b64_tr_b16 v[74:75], v200 offset:50688
    v_mfma_f32_16x16x32_bf16 v[216:219], v[44:47], v[32:35], v[216:219]
    ds_read_b64_tr_b16 v[76:77], v201 offset:49152
    v_mfma_f32_16x16x32_bf16 v[228:231], v[44:47], v[36:39], v[228:231]
    ds_read_b64_tr_b16 v[78:79], v201 offset:50688
    v_mfma_f32_16x16x32_bf16 v[220:223], v[32:35], v[48:51], v[220:223]
    ds_read_b64_tr_b16 v[80:81], v202 offset:49152
    v_mfma_f32_16x16x32_bf16 v[232:235], v[36:39], v[48:51], v[232:235]
    ds_read_b64_tr_b16 v[82:83], v202 offset:50688
    s_waitcnt vmcnt(3)
    s_barrier
    s_waitcnt lgkmcnt(0)
    v_mfma_f32_16x16x32_bf16 v[212:215], v[72:75], v[64:67], v[212:215]
    ds_read_b128 v[32:35], v208 offset:768
    ds_read_b128 v[36:39], v208 offset:17152
    v_mfma_f32_16x16x32_bf16 v[224:227], v[72:75], v[68:71], v[224:227]
    ds_read_b64_tr_b16 v[40:41], v204 offset:0
    ds_read_b64_tr_b16 v[42:43], v204 offset:1536
    v_mfma_f32_16x16x32_bf16 v[216:219], v[76:79], v[64:67], v[216:219]
    ds_read_b64_tr_b16 v[44:45], v205 offset:0
    v_mfma_f32_16x16x32_bf16 v[228:231], v[76:79], v[68:71], v[228:231]
    ds_read_b64_tr_b16 v[46:47], v205 offset:1536
    v_mfma_f32_16x16x32_bf16 v[220:223], v[64:67], v[80:83], v[220:223]
    ds_read_b64_tr_b16 v[48:49], v206 offset:0
    v_mfma_f32_16x16x32_bf16 v[232:235], v[68:71], v[80:83], v[232:235]
    ds_read_b64_tr_b16 v[50:51], v206 offset:1536
    s_waitcnt vmcnt(3)
    s_barrier
    s_waitcnt lgkmcnt(0)
    v_mfma_f32_16x16x32_bf16 v[212:215], v[40:43], v[32:35], v[212:215]
    ds_read_b128 v[64:67], v209 offset:768
    ds_read_b128 v[68:71], v209 offset:17152
    v_mfma_f32_16x16x32_bf16 v[224:227], v[40:43], v[36:39], v[224:227]
    ds_read_b64_tr_b16 v[72:73], v204 offset:12288
    ds_read_b64_tr_b16 v[74:75], v204 offset:13824
    v_mfma_f32_16x16x32_bf16 v[216:219], v[44:47], v[32:35], v[216:219]
    ds_read_b64_tr_b16 v[76:77], v205 offset:12288
    v_mfma_f32_16x16x32_bf16 v[228:231], v[44:47], v[36:39], v[228:231]
    ds_read_b64_tr_b16 v[78:79], v205 offset:13824
    v_mfma_f32_16x16x32_bf16 v[220:223], v[32:35], v[48:51], v[220:223]
    ds_read_b64_tr_b16 v[80:81], v206 offset:12288
    v_mfma_f32_16x16x32_bf16 v[232:235], v[36:39], v[48:51], v[232:235]
    ds_read_b64_tr_b16 v[82:83], v206 offset:13824
    s_waitcnt vmcnt(0)
    s_barrier
    s_waitcnt lgkmcnt(0)
    v_mfma_f32_16x16x32_bf16 v[212:215], v[72:75], v[64:67], v[212:215]
    ds_read_b128 v[32:35], v210 offset:768
    ds_read_b128 v[36:39], v210 offset:17152
    v_mfma_f32_16x16x32_bf16 v[224:227], v[72:75], v[68:71], v[224:227]
    ds_read_b64_tr_b16 v[40:41], v200 offset:0
    ds_read_b64_tr_b16 v[42:43], v200 offset:1536
    v_mfma_f32_16x16x32_bf16 v[216:219], v[76:79], v[64:67], v[216:219]
    ds_read_b64_tr_b16 v[44:45], v201 offset:0
    v_mfma_f32_16x16x32_bf16 v[228:231], v[76:79], v[68:71], v[228:231]
    ds_read_b64_tr_b16 v[46:47], v201 offset:1536
    v_mfma_f32_16x16x32_bf16 v[220:223], v[64:67], v[80:83], v[220:223]
    ds_read_b64_tr_b16 v[48:49], v202 offset:0
    v_mfma_f32_16x16x32_bf16 v[232:235], v[68:71], v[80:83], v[232:235]
    ds_read_b64_tr_b16 v[50:51], v202 offset:1536
    s_waitcnt vmcnt(0)
    s_barrier
    s_waitcnt lgkmcnt(0)
    v_mfma_f32_16x16x32_bf16 v[212:215], v[40:43], v[32:35], v[212:215]
    ds_read_b128 v[64:67], v211 offset:768
    ds_read_b128 v[68:71], v211 offset:17152
    v_mfma_f32_16x16x32_bf16 v[224:227], v[40:43], v[36:39], v[224:227]
    ds_read_b64_tr_b16 v[72:73], v200 offset:12288
    ds_read_b64_tr_b16 v[74:75], v200 offset:13824
    v_mfma_f32_16x16x32_bf16 v[216:219], v[44:47], v[32:35], v[216:219]
    ds_read_b64_tr_b16 v[76:77], v201 offset:12288
    v_mfma_f32_16x16x32_bf16 v[228:231], v[44:47], v[36:39], v[228:231]
    ds_read_b64_tr_b16 v[78:79], v201 offset:13824
    v_mfma_f32_16x16x32_bf16 v[220:223], v[32:35], v[48:51], v[220:223]
    ds_read_b64_tr_b16 v[80:81], v202 offset:12288
    v_mfma_f32_16x16x32_bf16 v[232:235], v[36:39], v[48:51], v[232:235]
    ds_read_b64_tr_b16 v[82:83], v202 offset:13824
    s_waitcnt lgkmcnt(0)
    v_mfma_f32_16x16x32_bf16 v[212:215], v[72:75], v[64:67], v[212:215]
    v_mfma_f32_16x16x32_bf16 v[224:227], v[72:75], v[68:71], v[224:227]
    v_mfma_f32_16x16x32_bf16 v[216:219], v[76:79], v[64:67], v[216:219]
    v_mfma_f32_16x16x32_bf16 v[228:231], v[76:79], v[68:71], v[228:231]
    v_mfma_f32_16x16x32_bf16 v[220:223], v[64:67], v[80:83], v[220:223]
    v_mfma_f32_16x16x32_bf16 v[232:235], v[68:71], v[80:83], v[232:235]
    v_lshlrev_b32 v8, 4, v1
    s_and_b32 s20, s3, 1
    s_lshl_b32 s21, s4, 1
    s_add_u32 s21, s21, s20
    s_lshl_b32 s21, s21, 10
    s_lshr_b32 s20, s3, 1
    s_mov_b32 s22, 0x3eb8aa3b
    s_cmp_lt_u32 s5, 4
    s_cselect_b32 s22, s22, 1.0
    s_lshl_b32 s23, s5, 3
    s_lshl_b32 s6, s20, 1
    s_add_u32 s23, s23, s6
    s_add_u32 s23, s23, 0
    s_lshl_b32 s23, s23, 16
    s_add_u32 s23, s23, s21
    v_mul_f32 v212, s22, v212
    v_mul_f32 v213, s22, v213
    v_mul_f32 v214, s22, v214
    v_mul_f32 v215, s22, v215
    v_cvt_pk_bf16_f32 v32, v212, v213
    v_cvt_pk_bf16_f32 v33, v214, v215
    v_mul_f32 v224, s22, v224
    v_mul_f32 v225, s22, v225
    v_mul_f32 v226, s22, v226
    v_mul_f32 v227, s22, v227
    v_cvt_pk_bf16_f32 v34, v224, v225
    v_cvt_pk_bf16_f32 v35, v226, v227
    s_nop 0
    v_permlane16_swap_b32 v32, v34
    v_permlane16_swap_b32 v33, v35
    buffer_store_dwordx4 v[32:35], v8, s[24:27], s23 offen sc1
    s_lshl_b32 s23, s5, 3
    s_lshl_b32 s6, s20, 1
    s_add_u32 s23, s23, s6
    s_add_u32 s23, s23, 1
    s_lshl_b32 s23, s23, 16
    s_add_u32 s23, s23, s21
    v_mul_f32 v216, s22, v216
    v_mul_f32 v217, s22, v217
    v_mul_f32 v218, s22, v218
    v_mul_f32 v219, s22, v219
    v_cvt_pk_bf16_f32 v36, v216, v217
    v_cvt_pk_bf16_f32 v37, v218, v219
    v_mul_f32 v228, s22, v228
    v_mul_f32 v229, s22, v229
    v_mul_f32 v230, s22, v230
    v_mul_f32 v231, s22, v231
    v_cvt_pk_bf16_f32 v38, v228, v229
    v_cvt_pk_bf16_f32 v39, v230, v231
    s_nop 0
    v_permlane16_swap_b32 v36, v38
    v_permlane16_swap_b32 v37, v39
    buffer_store_dwordx4 v[36:39], v8, s[24:27], s23 offen sc1
    s_lshl_b32 s23, s5, 2
    s_add_u32 s23, s23, s20
    s_lshl_b32 s23, s23, 16
    s_add_u32 s23, s23, s21
    v_cvt_pk_bf16_f32 v40, v220, v221
    v_cvt_pk_bf16_f32 v41, v222, v223
    v_cvt_pk_bf16_f32 v42, v232, v233
    v_cvt_pk_bf16_f32 v43, v234, v235
    s_nop 0
    v_permlane32_swap_b32 v40, v42
    v_permlane32_swap_b32 v41, v43
    buffer_store_dwordx4 v[40:43], v8, s[28:31], s23 offen sc1
    s_waitcnt vmcnt(0) lgkmcnt(0)
    s_barrier
    s_cmp_lg_u32 s3, 7
    s_cbranch_scc1 sig_26
    s_lshl_b32 s46, s5, 7
    s_lshl_b32 s47, s4, 2
    s_add_u32 s46, s46, s47
    s_add_u32 s46, s46, 8192
    v_mov_b32 v250, s59
    v_mul_u32_u24 v251, 1024, v1
    s_mov_b64 exec, 255
    buffer_store_dword v250, v251, s[60:63], s46 offen sc1
    s_mov_b64 exec, -1
sig_26:
    s_sub_u32 s20, s2, 64
    s_cmp_ge_u32 s20, 128
    s_cbranch_scc1 mla_27
    s_cmp_eq_u32 s3, 7
    s_cbranch_scc1 mla_27
    s_mov_b32 s32, s82
    s_mov_b32 s33, s83
    s_mov_b32 s34, 0x300000
    s_mov_b32 s35, 0x20000
    s_mov_b32 s36, s80
    s_mov_b32 s37, s81
    s_mov_b32 s38, 0x400
    s_mov_b32 s39, 0x20000
    v_and_b32 v72, 7, v0
    v_lshrrev_b32 v73, 3, v0
    v_mul_u32_u24 v74, 6144, v73
    v_lshl_add_u32 v74, v72, 4, v74
    v_lshlrev_b32 v75, 1, v73
    s_and_b32 s20, s2, 3
    s_lshr_b32 s21, s2, 2
    s_mul_i32 s40, s20, 786432
    s_lshl_b32 s21, s21, 7
    s_add_u32 s40, s40, s21
    s_add_u32 s41, s40, 344064
    s_add_u32 s43, s40, 688128
    s_lshl_b32 s42, s20, 8
    v_mov_b32 v88, 0
    v_mov_b32 v89, 0
    v_mov_b32 v90, 0
    v_mov_b32 v91, 0
    v_mov_b32 v78, 0
    buffer_load_dwordx4 v[80:83], v74, s[32:35], s40 offen
    buffer_load_dwordx4 v[84:87], v74, s[32:35], s41 offen
    buffer_load_ushort v76, v75, s[36:39], s42 offen
    buffer_load_ushort v77, v75, s[36:39], s42 offen offset:112
    v_cmp_gt_u32 vcc, 16, v73
    s_nop 3
    s_and_saveexec_b64 s[44:45], vcc
    s_cbranch_execz mla3_28
    buffer_load_dwordx4 v[88:91], v74, s[32:35], s43 offen
    buffer_load_ushort v78, v75, s[36:39], s42 offen offset:224
mla3_28:
    s_mov_b64 exec, s[44:45]
    v_mov_b32 v64, 0
    v_mov_b32 v65, 0
    v_mov_b32 v66, 0
    v_mov_b32 v67, 0
    v_mov_b32 v68, 0
    v_mov_b32 v69, 0
    v_mov_b32 v70, 0
    v_mov_b32 v71, 0
    s_waitcnt vmcnt(0)
    v_lshlrev_b32 v76, 16, v76
    v_mul_f32 v12, 0xbfb8aa3b, v76
    v_exp_f32 v12, v12
    s_nop 0
    v_add_f32 v12, 1.0, v12
    v_rcp_f32 v12, v12
    s_nop 0
    v_mul_f32 v76, v76, v12
    v_cvt_pk_bf16_f32 v76, v76, v76
    v_lshlrev_b32 v76, 16, v76
    v_lshlrev_b32 v77, 16, v77
    v_mul_f32 v12, 0xbfb8aa3b, v77
    v_exp_f32 v12, v12
    s_nop 0
    v_add_f32 v12, 1.0, v12
    v_rcp_f32 v12, v12
    s_nop 0
    v_mul_f32 v77, v77, v12
    v_cvt_pk_bf16_f32 v77, v77, v77
    v_lshlrev_b32 v77, 16, v77
    v_lshlrev_b32 v78, 16, v78
    v_mul_f32 v12, 0xbfb8aa3b, v78
    v_exp_f32 v12, v12
    s_nop 0
    v_add_f32 v12, 1.0, v12
    v_rcp_f32 v12, v12
    s_nop 0
    v_mul_f32 v78, v78, v12
    v_cvt_pk_bf16_f32 v78, v78, v78
    v_lshlrev_b32 v78, 16, v78
    v_lshlrev_b32 v12, 16, v80
    v_and_b32 v13, 0xffff0000, v80
    v_fmac_f32 v64, v76, v12
    v_fmac_f32 v65, v76, v13
    v_lshlrev_b32 v12, 16, v81
    v_and_b32 v13, 0xffff0000, v81
    v_fmac_f32 v66, v76, v12
    v_fmac_f32 v67, v76, v13
    v_lshlrev_b32 v12, 16, v82
    v_and_b32 v13, 0xffff0000, v82
    v_fmac_f32 v68, v76, v12
    v_fmac_f32 v69, v76, v13
    v_lshlrev_b32 v12, 16, v83
    v_and_b32 v13, 0xffff0000, v83
    v_fmac_f32 v70, v76, v12
    v_fmac_f32 v71, v76, v13
    v_lshlrev_b32 v12, 16, v84
    v_and_b32 v13, 0xffff0000, v84
    v_fmac_f32 v64, v77, v12
    v_fmac_f32 v65, v77, v13
    v_lshlrev_b32 v12, 16, v85
    v_and_b32 v13, 0xffff0000, v85
    v_fmac_f32 v66, v77, v12
    v_fmac_f32 v67, v77, v13
    v_lshlrev_b32 v12, 16, v86
    v_and_b32 v13, 0xffff0000, v86
    v_fmac_f32 v68, v77, v12
    v_fmac_f32 v69, v77, v13
    v_lshlrev_b32 v12, 16, v87
    v_and_b32 v13, 0xffff0000, v87
    v_fmac_f32 v70, v77, v12
    v_fmac_f32 v71, v77, v13
    v_lshlrev_b32 v12, 16, v88
    v_and_b32 v13, 0xffff0000, v88
    v_fmac_f32 v64, v78, v12
    v_fmac_f32 v65, v78, v13
    v_lshlrev_b32 v12, 16, v89
    v_and_b32 v13, 0xffff0000, v89
    v_fmac_f32 v66, v78, v12
    v_fmac_f32 v67, v78, v13
    v_lshlrev_b32 v12, 16, v90
    v_and_b32 v13, 0xffff0000, v90
    v_fmac_f32 v68, v78, v12
    v_fmac_f32 v69, v78, v13
    v_lshlrev_b32 v12, 16, v91
    v_and_b32 v13, 0xffff0000, v91
    v_fmac_f32 v70, v78, v12
    v_fmac_f32 v71, v78, v13
    v_add_f32_dpp v64, v64, v64 row_ror:8 row_mask:0xf bank_mask:0xf
    v_add_f32_dpp v65, v65, v65 row_ror:8 row_mask:0xf bank_mask:0xf
    v_add_f32_dpp v66, v66, v66 row_ror:8 row_mask:0xf bank_mask:0xf
    v_add_f32_dpp v67, v67, v67 row_ror:8 row_mask:0xf bank_mask:0xf
    v_add_f32_dpp v68, v68, v68 row_ror:8 row_mask:0xf bank_mask:0xf
    v_add_f32_dpp v69, v69, v69 row_ror:8 row_mask:0xf bank_mask:0xf
    v_add_f32_dpp v70, v70, v70 row_ror:8 row_mask:0xf bank_mask:0xf
    v_add_f32_dpp v71, v71, v71 row_ror:8 row_mask:0xf bank_mask:0xf
    v_lshrrev_b32 v12, 4, v0
    v_lshlrev_b32 v12, 8, v12
    v_lshl_add_u32 v12, v72, 5, v12
    v_add_u32 v12, 155648, v12
    v_and_b32 v13, 8, v1
    v_cmp_eq_u32 vcc, 0, v13
    s_nop 3
    s_and_saveexec_b64 s[44:45], vcc
    ds_write_b128 v12, v[64:67]
    ds_write_b128 v12, v[68:71] offset:16
    s_mov_b64 exec, s[44:45]
    s_waitcnt lgkmcnt(0)
mla_27:
    s_add_u32 s8, s88, 0x100000
    s_addc_u32 s9, s89, 0
    s_mov_b32 s10, 0x400000
    s_mov_b32 s11, 0x20000
    s_add_u32 s12, s88, 0x500000
    s_addc_u32 s13, s89, 0
    s_mov_b32 s14, 0x200000
    s_mov_b32 s15, 0x20000
    s_add_u32 s16, s88, 0x700000
    s_addc_u32 s17, s89, 0
    s_mov_b32 s18, 0x200000
    s_mov_b32 s19, 0x20000
    s_and_b32 s6, s3, 3
    s_lshr_b32 s7, s3, 2
    v_lshlrev_b32 v2, 4, v1
    v_mov_b32 v3, 151552
    v_mov_b32 v4, 0
    ds_write_b32 v3, v4
    v_and_b32 v6, 31, v1
    v_and_b32 v7, 27, v6
    v_cmp_eq_u32 vcc, 16, v7
    v_mov_b32 v16, 0x3f803f80
    s_nop 0
    v_cndmask_b32 v16, 0, v16, vcc
    v_mov_b32 v152, v16
    v_mov_b32 v153, v16
    v_mov_b32 v154, v16
    v_mov_b32 v155, v16
    v_mov_b32 v156, v16
    v_mov_b32 v157, v16
    v_mov_b32 v158, v16
    v_mov_b32 v159, v16
    v_mov_b32 v160, v16
    v_mov_b32 v161, v16
    v_mov_b32 v162, v16
    v_mov_b32 v163, v16
    v_mov_b32 v164, v16
    v_mov_b32 v165, v16
    v_mov_b32 v166, v16
    v_mov_b32 v167, v16
    v_cmp_gt_u32 s[30:31], 16, v6
    v_mov_b32 v112, 0
    v_mov_b32 v128, 0
    v_mov_b32 v113, 0
    v_mov_b32 v129, 0
    v_mov_b32 v114, 0
    v_mov_b32 v130, 0
    v_mov_b32 v115, 0
    v_mov_b32 v131, 0
    v_mov_b32 v116, 0
    v_mov_b32 v132, 0
    v_mov_b32 v117, 0
    v_mov_b32 v133, 0
    v_mov_b32 v118, 0
    v_mov_b32 v134, 0
    v_mov_b32 v119, 0
    v_mov_b32 v135, 0
    v_mov_b32 v120, 0
    v_mov_b32 v136, 0
    v_mov_b32 v121, 0
    v_mov_b32 v137, 0
    v_mov_b32 v122, 0
    v_mov_b32 v138, 0
    v_mov_b32 v123, 0
    v_mov_b32 v139, 0
    v_mov_b32 v124, 0
    v_mov_b32 v140, 0
    v_mov_b32 v125, 0
    v_mov_b32 v141, 0
    v_mov_b32 v126, 0
    v_mov_b32 v142, 0
    v_mov_b32 v127, 0
    v_mov_b32 v143, 0
    s_mov_b32 s33, 0
    s_cmp_eq_u32 s3, 7
    s_cbranch_scc1 wf7_31
    s_branch wf_30
wf7_31:
    s_and_b32 s46, s2, 7
    s_lshl_b32 s46, s46, 10
    s_add_u32 s46, s46, 8192
    s_lshr_b32 s44, s58, 3
    s_add_u32 s44, s44, 4
    s_lshl_b32 s44, s44, 7
    s_lshr_b32 s45, s58, 2
    s_lshl_b32 s45, s45, 7
    v_and_b32 v251, 31, v1
    v_lshlrev_b32 v251, 2, v251
    v_mov_b32 v252, s44
    v_mov_b32 v253, s45
    v_cmp_gt_u32 vcc, 32, v1
    s_nop 1
    v_cndmask_b32 v252, v253, v252, vcc
    v_add_u32 v251, v251, v252
    s_mov_b32 s42, 0xffffffff
    s_mov_b32 s43, 0xffffffff
    s_mov_b32 s47, 0
poll_32:
    buffer_load_dword v250, v251, s[60:63], s46 offen sc0 sc1
    s_add_u32 s47, s47, 1
    s_cmp_gt_u32 s47, 1048576
    s_cbranch_scc1 polled_33
    s_waitcnt vmcnt(0)
    v_cmp_eq_u32 vcc, s59, v250
    s_nop 3
    s_and_b64 vcc, vcc, s[42:43]
    s_cmp_eq_u64 vcc, s[42:43]
    s_cbranch_scc0 poll_32
polled_33:
    s_and_b32 s46, s2, 7
    s_lshl_b32 s46, s46, 10
    s_add_u32 s46, s46, 8192
    s_lshr_b32 s44, s58, 3
    s_lshl_b32 s44, s44, 7
    s_add_u32 s46, s46, s44
    s_lshl_b32 s44, s57, 4
    s_add_u32 s46, s46, s44
    v_lshlrev_b32 v251, 2, v1
    s_mov_b32 s42, 0xf
    s_mov_b32 s43, 0x0
    s_mov_b32 s47, 0
poll_34:
    buffer_load_dword v250, v251, s[60:63], s46 offen sc0 sc1
    s_add_u32 s47, s47, 1
    s_cmp_gt_u32 s47, 1048576
    s_cbranch_scc1 polled_35
    s_waitcnt vmcnt(0)
    v_cmp_eq_u32 vcc, s59, v250
    s_nop 3
    s_and_b64 vcc, vcc, s[42:43]
    s_cmp_eq_u64 vcc, s[42:43]
    s_cbranch_scc0 poll_34
polled_35:
wf_30:
    s_barrier
    s_lshl_b32 s20, s57, 3
    s_lshl_b32 s21, s6, 1
    s_add_u32 s20, s20, s21
    s_lshl_b32 s20, s20, 10
    s_lshl_b32 s21, s58, 16
    s_add_u32 s20, s20, s21
    buffer_load_dwordx4 v[8:11], v2, s[8:11], s20 offen
    buffer_load_dwordx4 v[12:15], v2, s[8:11], s20 offen offset:1024
    s_lshl_b32 s41, s58, 16
    s_add_u32 s40, s41, 2097152
    s_lshl_b32 s42, s3, 10
    s_add_u32 s40, s40, s42
    s_add_u32 s41, s41, s42
    s_add_u32 s20, s40, 0
    s_add_u32 m0, s42, 0
    s_nop 0
    buffer_load_dwordx4 v2, s[8:11], s20 offen lds
    s_add_u32 s20, s41, 0
    s_add_u32 m0, s42, 65536
    s_nop 0
    buffer_load_dwordx4 v2, s[12:15], s20 offen lds
    s_add_u32 s20, s40, 32768
    s_add_u32 m0, s42, 32768
    s_nop 0
    buffer_load_dwordx4 v2, s[8:11], s20 offen lds
    s_add_u32 s20, s41, 32768
    s_add_u32 m0, s42, 98304
    s_nop 0
    buffer_load_dwordx4 v2, s[12:15], s20 offen lds
    s_add_u32 s40, s40, 8192
    s_add_u32 s41, s41, 8192
    s_add_u32 s42, s42, 8192
    s_sub_u32 s20, s2, 64
    s_cmp_ge_u32 s20, 128
    s_cbranch_scc1 mlb_36
    s_cmp_lg_u32 s3, 6
    s_cbranch_scc1 mlb_36
    s_mov_b32 s48, s88
    s_mov_b32 s49, s89
    s_mov_b32 s50, 0xc000
    s_mov_b32 s51, 0x20000
    v_lshlrev_b32 v178, 2, v1
    v_add_u32 v179, 155648, v178
    ds_read_b32 v180, v179 offset:0
    ds_read_b32 v181, v179 offset:256
    ds_read_b32 v182, v179 offset:512
    ds_read_b32 v183, v179 offset:768
    ds_read_b32 v184, v179 offset:1024
    ds_read_b32 v185, v179 offset:1280
    ds_read_b32 v186, v179 offset:1536
    ds_read_b32 v187, v179 offset:1792
    ds_read_b32 v188, v179 offset:2048
    ds_read_b32 v189, v179 offset:2304
    ds_read_b32 v190, v179 offset:2560
    ds_read_b32 v191, v179 offset:2816
    ds_read_b32 v192, v179 offset:3072
    ds_read_b32 v193, v179 offset:3328
    ds_read_b32 v194, v179 offset:3584
    ds_read_b32 v195, v179 offset:3840
    ds_read_b32 v196, v179 offset:4096
    ds_read_b32 v197, v179 offset:4352
    ds_read_b32 v198, v179 offset:4608
    ds_read_b32 v199, v179 offset:4864
    ds_read_b32 v200, v179 offset:5120
    ds_read_b32 v201, v179 offset:5376
    ds_read_b32 v202, v179 offset:5632
    ds_read_b32 v203, v179 offset:5888
    ds_read_b32 v204, v179 offset:6144
    ds_read_b32 v205, v179 offset:6400
    ds_read_b32 v206, v179 offset:6656
    ds_read_b32 v207, v179 offset:6912
    s_waitcnt lgkmcnt(0)
    v_add_f32 v180, v180, v181
    v_add_f32 v180, v180, v182
    v_add_f32 v180, v180, v183
    v_add_f32 v180, v180, v184
    v_add_f32 v180, v180, v185
    v_add_f32 v180, v180, v186
    v_add_f32 v180, v180, v187
    v_add_f32 v180, v180, v188
    v_add_f32 v180, v180, v189
    v_add_f32 v180, v180, v190
    v_add_f32 v180, v180, v191
    v_add_f32 v180, v180, v192
    v_add_f32 v180, v180, v193
    v_add_f32 v180, v180, v194
    v_add_f32 v180, v180, v195
    v_add_f32 v180, v180, v196
    v_add_f32 v180, v180, v197
    v_add_f32 v180, v180, v198
    v_add_f32 v180, v180, v199
    v_add_f32 v180, v180, v200
    v_add_f32 v180, v180, v201
    v_add_f32 v180, v180, v202
    v_add_f32 v180, v180, v203
    v_add_f32 v180, v180, v204
    v_add_f32 v180, v180, v205
    v_add_f32 v180, v180, v206
    v_add_f32 v180, v180, v207
    s_and_b32 s20, s2, 3
    s_mul_i32 s20, s20, 12288
    s_lshr_b32 s21, s2, 2
    s_lshl_b32 s21, s21, 8
    s_add_u32 s20, s20, s21
    buffer_store_dword v180, v178, s[48:51], s20 offen sc1
mlb_36:
att_restart_37:
    v_mov_b32 v80, 0
    v_mov_b32 v96, 0
    v_mov_b32 v81, 0
    v_mov_b32 v97, 0
    v_mov_b32 v82, 0
    v_mov_b32 v98, 0
    v_mov_b32 v83, 0
    v_mov_b32 v99, 0
    v_mov_b32 v84, 0
    v_mov_b32 v100, 0
    v_mov_b32 v85, 0
    v_mov_b32 v101, 0
    v_mov_b32 v86, 0
    v_mov_b32 v102, 0
    v_mov_b32 v87, 0
    v_mov_b32 v103, 0
    v_mov_b32 v88, 0
    v_mov_b32 v104, 0
    v_mov_b32 v89, 0
    v_mov_b32 v105, 0
    v_mov_b32 v90, 0
    v_mov_b32 v106, 0
    v_mov_b32 v91, 0
    v_mov_b32 v107, 0
    v_mov_b32 v92, 0
    v_mov_b32 v108, 0
    v_mov_b32 v93, 0
    v_mov_b32 v109, 0
    v_mov_b32 v94, 0
    v_mov_b32 v110, 0
    v_mov_b32 v95, 0
    v_mov_b32 v111, 0
    s_lshl_b32 s20, s7, 15
    v_add_u32 v4, s20, v2
    v_lshrrev_b32 v6, 5, v1
    v_and_b32 v7, 15, v1
    v_lshlrev_b32 v7, 4, v7
    v_lshl_add_u32 v7, v6, 8, v7
    s_add_u32 s20, s20, 65536
    v_add_u32 v5, s20, v7
    v_mov_b32 v72, 0
    v_mov_b32 v73, 0
    v_mov_b32 v74, 0
    v_mov_b32 v75, 0
    v_mov_b32 v76, 0
    v_mov_b32 v77, 0
    v_mov_b32 v78, 0
    v_mov_b32 v79, 0
    s_lshl_b32 s20, s3, 2
    s_add_u32 s20, s20, 151616
    v_mov_b32 v17, s20
    s_xor_b32 s20, s20, 16
    v_mov_b32 v18, s20
    v_mov_b32 v19, 0
    ds_write_b32 v17, v19
    s_mov_b64 exec, s[30:31]
    v_mov_b32 v160, 0
    v_mov_b32 v161, 0
    v_mov_b32 v162, 0
    v_mov_b32 v163, 0
    v_mov_b32 v164, 0
    v_mov_b32 v165, 0
    v_mov_b32 v166, 0
    v_mov_b32 v167, 0
    s_mov_b64 exec, -1
    s_waitcnt vmcnt(0) lgkmcnt(0)
    s_barrier
    ds_read_b128 v[144:147], v4 offset:0
    s_mov_b64 exec, s[30:31]
    ds_read_b128 v[152:155], v5 offset:0
    ds_read_b128 v[156:159], v5 offset:512
    s_mov_b64 exec, -1
    s_waitcnt lgkmcnt(0)
    v_mfma_f32_32x32x16_bf16 v[32:47], v[144:147], v[8:11], v[112:127]
    s_mov_b32 s34, 0
    s_cmp_lg_u32 s33, 0
    s_cbranch_scc1 att_slowloop_38
att_loop_40:
    s_cmp_lg_u32 s34, 4
    s_cbranch_scc1 att_pf_42
    s_and_b32 s20, s2, 7
    s_lshr_b32 s21, s2, 3
    v_lshlrev_b32 v170, 7, v1
    s_mov_b32 s48, s74
    s_mov_b32 s49, s75
    s_mov_b32 s50, 0x800000
    s_mov_b32 s51, 0x20000
    s_and_b32 s22, s20, 3
    s_lshl_b32 s22, s22, 21
    s_lshl_b32 s23, s21, 16
    s_add_u32 s22, s22, s23
    s_lshl_b32 s23, s3, 13
    s_add_u32 s22, s22, s23
    buffer_load_dword v172, v170, s[48:51], s22 offen
    s_mov_b32 s48, s72
    s_mov_b32 s49, s73
    s_mov_b32 s50, 0x1c0000
    s_mov_b32 s51, 0x20000
    v_lshrrev_b32 v173, 5, v1
    v_bfe_u32 v174, v1, 4, 1
    v_and_b32 v175, 15, v1
    v_min_u32 v175, 7, v175
    v_mul_u32_u24 v173, 3584, v173
    v_mul_u32_u24 v174, 1792, v174
    v_add_u32 v173, v173, v174
    v_lshl_add_u32 v173, v175, 7, v173
    s_lshr_b32 s22, s20, 2
    s_mul_i32 s22, s22, 896
    s_lshl_b32 s23, s21, 4
    s_lshl_b32 s46, s3, 1
    s_add_u32 s23, s23, s46
    s_mul_i32 s23, s23, 3584
    s_add_u32 s22, s22, s23
    buffer_load_dword v174, v173, s[48:51], s22 offen
    v_lshrrev_b32 v173, 2, v1
    v_and_b32 v175, 3, v1
    v_lshlrev_b32 v173, 10, v173
    v_lshl_add_u32 v173, v175, 7, v173
    s_lshr_b32 s22, s20, 2
    s_lshl_b32 s22, s22, 9
    s_cmp_ge_u32 s3, 2
    s_cbranch_scc1 pf_w_43
    s_mov_b32 s48, s78
    s_mov_b32 s49, s79
    s_mov_b32 s50, 0xe0000
    s_mov_b32 s51, 0x20000
    s_mul_i32 s23, s21, 28
    s_lshl_b32 s46, s3, 4
    s_add_u32 s23, s23, s46
    s_lshl_b32 s23, s23, 10
    s_add_u32 s22, s22, s23
    buffer_load_dword v175, v173, s[48:51], s22 offen
    s_branch pf_x_44
pf_w_43:
    s_cmp_lg_u32 s3, 2
    s_cbranch_scc1 pf_x_44
    s_mov_b32 s48, s68
    s_mov_b32 s49, s69
    s_mov_b32 s50, 0x80000
    s_mov_b32 s51, 0x20000
    s_lshl_b32 s23, s21, 14
    s_add_u32 s22, s22, s23
    buffer_load_dword v175, v173, s[48:51], s22 offen
pf_x_44:
att_pf_42:
    s_cmp_lg_u32 s34, 3
    s_cbranch_scc1 att_nobar_41
    s_waitcnt vmcnt(0)
    s_barrier
    s_sub_u32 s20, s2, 64
    s_cmp_ge_u32 s20, 128
    s_cbranch_scc1 mlf_45
    s_cmp_lg_u32 s3, 6
    s_cbranch_scc1 mlf_45
    s_lshl_b32 s46, s2, 2
    s_add_u32 s46, s46, 0
    v_mov_b32 v250, s59
    v_mul_u32_u24 v251, 1024, v1
    s_mov_b64 exec, 0xff
    buffer_store_dword v250, v251, s[60:63], s46 offen sc1
    s_mov_b64 exec, -1
mlf_45:
att_nobar_41:
    ds_read_b128 v[148:151], v4 offset:1024
    v_mfma_f32_32x32x16_bf16 v[48:63], v[144:147], v[12:15], 0
    s_nop 2
    v_exp_f32 v32, v32
    v_exp_f32 v33, v33
    v_exp_f32 v34, v34
    v_exp_f32 v35, v35
    v_cvt_pk_bf16_f32 v64, v32, v33
    v_mfma_f32_32x32x16_bf16 v[96:111], v[160:163], v[72:75], v[96:111]
    v_exp_f32 v36, v36
    v_exp_f32 v37, v37
    v_cvt_pk_bf16_f32 v65, v34, v35
    v_exp_f32 v38, v38
    v_exp_f32 v39, v39
    v_cvt_pk_bf16_f32 v66, v36, v37
    s_cmp_ge_u32 s34, 3
    s_cbranch_scc1 att_nd_46
    s_add_u32 s20, s40, 0
    s_add_u32 m0, s42, 0
    s_nop 0
    buffer_load_dwordx4 v2, s[8:11], s20 offen lds
    s_add_u32 s20, s41, 0
    s_add_u32 m0, s42, 65536
    s_nop 0
    buffer_load_dwordx4 v2, s[12:15], s20 offen lds
    s_add_u32 s20, s40, 32768
    s_add_u32 m0, s42, 32768
    s_nop 0
    buffer_load_dwordx4 v2, s[8:11], s20 offen lds
    s_add_u32 s20, s41, 32768
    s_add_u32 m0, s42, 98304
    s_nop 0
    buffer_load_dwordx4 v2, s[12:15], s20 offen lds
    s_add_u32 s40, s40, 8192
    s_add_u32 s41, s41, 8192
    s_add_u32 s42, s42, 8192
att_nd_46:
    v_exp_f32 v40, v40
    v_exp_f32 v41, v41
    v_cvt_pk_bf16_f32 v67, v38, v39
    v_mfma_f32_32x32x16_bf16 v[96:111], v[164:167], v[76:79], v[96:111]
    v_exp_f32 v42, v42
    v_exp_f32 v43, v43
    v_cvt_pk_bf16_f32 v68, v40, v41
    v_exp_f32 v44, v44
    v_exp_f32 v45, v45
    v_cvt_pk_bf16_f32 v69, v42, v43
    v_exp_f32 v46, v46
    v_exp_f32 v47, v47
    v_cvt_pk_bf16_f32 v70, v44, v45
    v_cvt_pk_bf16_f32 v71, v46, v47
    s_mov_b64 exec, s[30:31]
    ds_read_b128 v[160:163], v5 offset:1024
    ds_read_b128 v[164:167], v5 offset:1536
    s_mov_b64 exec, -1
    s_waitcnt lgkmcnt(2)
    v_mov_b32 v19, s34
    ds_write_b32 v17, v19
    ds_read_b32 v24, v18
    v_mfma_f32_32x32x16_bf16 v[32:47], v[148:151], v[8:11], 0
    v_exp_f32 v48, v48
    v_exp_f32 v49, v49
    v_exp_f32 v50, v50
    v_exp_f32 v51, v51
    v_cvt_pk_bf16_f32 v72, v48, v49
    v_mfma_f32_32x32x16_bf16 v[80:95], v[152:155], v[64:67], v[80:95]
    v_exp_f32 v52, v52
    v_exp_f32 v53, v53
    v_cvt_pk_bf16_f32 v73, v50, v51
    v_exp_f32 v54, v54
    v_exp_f32 v55, v55
    v_cvt_pk_bf16_f32 v74, v52, v53
    v_exp_f32 v56, v56
    v_exp_f32 v57, v57
    v_cvt_pk_bf16_f32 v75, v54, v55
    v_mfma_f32_32x32x16_bf16 v[80:95], v[156:159], v[68:71], v[80:95]
    v_exp_f32 v58, v58
    v_exp_f32 v59, v59
    v_cvt_pk_bf16_f32 v76, v56, v57
    v_exp_f32 v60, v60
    v_exp_f32 v61, v61
    v_cvt_pk_bf16_f32 v77, v58, v59
    v_exp_f32 v62, v62
    v_exp_f32 v63, v63
    v_cvt_pk_bf16_f32 v78, v60, v61
    v_cvt_pk_bf16_f32 v79, v62, v63
    ds_read_b128 v[144:147], v4 offset:2048
    v_mfma_f32_32x32x16_bf16 v[48:63], v[148:151], v[12:15], 0
    v_exp_f32 v32, v32
    v_exp_f32 v33, v33
    v_exp_f32 v34, v34
    v_exp_f32 v35, v35
    v_cvt_pk_bf16_f32 v64, v32, v33
    v_mfma_f32_32x32x16_bf16 v[96:111], v[152:155], v[72:75], v[96:111]
    v_exp_f32 v36, v36
    v_exp_f32 v37, v37
    v_cvt_pk_bf16_f32 v65, v34, v35
    v_exp_f32 v38, v38
    v_exp_f32 v39, v39
    v_cvt_pk_bf16_f32 v66, v36, v37
    v_exp_f32 v40, v40
    v_exp_f32 v41, v41
    v_cvt_pk_bf16_f32 v67, v38, v39
    v_mfma_f32_32x32x16_bf16 v[96:111], v[156:159], v[76:79], v[96:111]
    v_exp_f32 v42, v42
    v_exp_f32 v43, v43
    v_cvt_pk_bf16_f32 v68, v40, v41
    v_exp_f32 v44, v44
    v_exp_f32 v45, v45
    v_cvt_pk_bf16_f32 v69, v42, v43
    v_exp_f32 v46, v46
    v_exp_f32 v47, v47
    v_cvt_pk_bf16_f32 v70, v44, v45
    v_cvt_pk_bf16_f32 v71, v46, v47
    s_mov_b64 exec, s[30:31]
    ds_read_b128 v[152:155], v5 offset:2048
    ds_read_b128 v[156:159], v5 offset:2560
    s_mov_b64 exec, -1
    s_waitcnt lgkmcnt(2)
    v_readfirstlane_b32 s20, v24
    s_nop 3
    s_cmp_gt_u32 s34, s20
    s_cselect_b32 s20, 0, 1
    s_cmp_eq_u32 s20, 1
    s_cbranch_scc1 att_hi_47
    s_setprio 0
    s_branch att_pd_48
att_hi_47:
    s_setprio 1
att_pd_48:
    v_mfma_f32_32x32x16_bf16 v[32:47], v[144:147], v[8:11], 0
    v_exp_f32 v48, v48
    v_exp_f32 v49, v49
    v_exp_f32 v50, v50
    v_exp_f32 v51, v51
    v_cvt_pk_bf16_f32 v72, v48, v49
    v_mfma_f32_32x32x16_bf16 v[80:95], v[160:163], v[64:67], v[80:95]
    v_exp_f32 v52, v52
    v_exp_f32 v53, v53
    v_cvt_pk_bf16_f32 v73, v50, v51
    v_exp_f32 v54, v54
    v_exp_f32 v55, v55
    v_cvt_pk_bf16_f32 v74, v52, v53
    v_exp_f32 v56, v56
    v_exp_f32 v57, v57
    v_cvt_pk_bf16_f32 v75, v54, v55
    v_mfma_f32_32x32x16_bf16 v[80:95], v[164:167], v[68:71], v[80:95]
    v_exp_f32 v58, v58
    v_exp_f32 v59, v59
    v_cvt_pk_bf16_f32 v76, v56, v57
    v_exp_f32 v60, v60
    v_exp_f32 v61, v61
    v_cvt_pk_bf16_f32 v77, v58, v59
    v_exp_f32 v62, v62
    v_exp_f32 v63, v63
    v_cvt_pk_bf16_f32 v78, v60, v61
    v_cvt_pk_bf16_f32 v79, v62, v63
    v_add_u32 v4, 2048, v4
    v_add_u32 v5, 2048, v5
    s_add_u32 s34, s34, 1
    s_cmp_lt_u32 s34, 5
    s_cbranch_scc1 att_loop_40
att_lean_49:
    ds_read_b128 v[148:151], v4 offset:1024
    v_mfma_f32_32x32x16_bf16 v[48:63], v[144:147], v[12:15], 0
    v_exp_f32 v32, v32
    v_exp_f32 v33, v33
    v_exp_f32 v34, v34
    v_exp_f32 v35, v35
    v_cvt_pk_bf16_f32 v64, v32, v33
    v_mfma_f32_32x32x16_bf16 v[96:111], v[160:163], v[72:75], v[96:111]
    v_exp_f32 v36, v36
    v_exp_f32 v37, v37
    v_cvt_pk_bf16_f32 v65, v34, v35
    v_exp_f32 v38, v38
    v_exp_f32 v39, v39
    v_cvt_pk_bf16_f32 v66, v36, v37
    v_exp_f32 v40, v40
    v_exp_f32 v41, v41
    v_cvt_pk_bf16_f32 v67, v38, v39
    v_mfma_f32_32x32x16_bf16 v[96:111], v[164:167], v[76:79], v[96:111]
    v_exp_f32 v42, v42
    v_exp_f32 v43, v43
    v_cvt_pk_bf16_f32 v68, v40, v41
    v_exp_f32 v44, v44
    v_exp_f32 v45, v45
    v_cvt_pk_bf16_f32 v69, v42, v43
    v_exp_f32 v46, v46
    v_exp_f32 v47, v47
    v_cvt_pk_bf16_f32 v70, v44, v45
    v_cvt_pk_bf16_f32 v71, v46, v47
    s_mov_b64 exec, s[30:31]
    ds_read_b128 v[160:163], v5 offset:1024
    ds_read_b128 v[164:167], v5 offset:1536
    s_mov_b64 exec, -1
    s_waitcnt lgkmcnt(2)
    v_mov_b32 v19, s34
    ds_write_b32 v17, v19
    ds_read_b32 v24, v18
    v_mfma_f32_32x32x16_bf16 v[32:47], v[148:151], v[8:11], 0
    v_exp_f32 v48, v48
    v_exp_f32 v49, v49
    v_exp_f32 v50, v50
    v_exp_f32 v51, v51
    v_cvt_pk_bf16_f32 v72, v48, v49
    v_mfma_f32_32x32x16_bf16 v[80:95], v[152:155], v[64:67], v[80:95]
    v_exp_f32 v52, v52
    v_exp_f32 v53, v53
    v_cvt_pk_bf16_f32 v73, v50, v51
    v_exp_f32 v54, v54
    v_exp_f32 v55, v55
    v_cvt_pk_bf16_f32 v74, v52, v53
    v_exp_f32 v56, v56
    v_exp_f32 v57, v57
    v_cvt_pk_bf16_f32 v75, v54, v55
    v_mfma_f32_32x32x16_bf16 v[80:95], v[156:159], v[68:71], v[80:95]
    v_exp_f32 v58, v58
    v_exp_f32 v59, v59
    v_cvt_pk_bf16_f32 v76, v56, v57
    v_exp_f32 v60, v60
    v_exp_f32 v61, v61
    v_cvt_pk_bf16_f32 v77, v58, v59
    v_exp_f32 v62, v62
    v_exp_f32 v63, v63
    v_cvt_pk_bf16_f32 v78, v60, v61
    v_cvt_pk_bf16_f32 v79, v62, v63
    ds_read_b128 v[144:147], v4 offset:2048
    v_mfma_f32_32x32x16_bf16 v[48:63], v[148:151], v[12:15], 0
    v_exp_f32 v32, v32
    v_exp_f32 v33, v33
    v_exp_f32 v34, v34
    v_exp_f32 v35, v35
    v_cvt_pk_bf16_f32 v64, v32, v33
    v_mfma_f32_32x32x16_bf16 v[96:111], v[152:155], v[72:75], v[96:111]
    v_exp_f32 v36, v36
    v_exp_f32 v37, v37
    v_cvt_pk_bf16_f32 v65, v34, v35
    v_exp_f32 v38, v38
    v_exp_f32 v39, v39
    v_cvt_pk_bf16_f32 v66, v36, v37
    v_exp_f32 v40, v40
    v_exp_f32 v41, v41
    v_cvt_pk_bf16_f32 v67, v38, v39
    v_mfma_f32_32x32x16_bf16 v[96:111], v[156:159], v[76:79], v[96:111]
    v_exp_f32 v42, v42
    v_exp_f32 v43, v43
    v_cvt_pk_bf16_f32 v68, v40, v41
    v_exp_f32 v44, v44
    v_exp_f32 v45, v45
    v_cvt_pk_bf16_f32 v69, v42, v43
    v_exp_f32 v46, v46
    v_exp_f32 v47, v47
    v_cvt_pk_bf16_f32 v70, v44, v45
    v_cvt_pk_bf16_f32 v71, v46, v47
    s_mov_b64 exec, s[30:31]
    ds_read_b128 v[152:155], v5 offset:2048
    ds_read_b128 v[156:159], v5 offset:2560
    s_mov_b64 exec, -1
    s_waitcnt lgkmcnt(2)
    v_readfirstlane_b32 s20, v24
    s_nop 3
    s_cmp_gt_u32 s34, s20
    s_cselect_b32 s20, 0, 1
    s_cmp_eq_u32 s20, 1
    s_cbranch_scc1 att_hi_50
    s_setprio 0
    s_branch att_pd_51
att_hi_50:
    s_setprio 1
att_pd_51:
    v_mfma_f32_32x32x16_bf16 v[32:47], v[144:147], v[8:11], 0
    v_exp_f32 v48, v48
    v_exp_f32 v49, v49
    v_exp_f32 v50, v50
    v_exp_f32 v51, v51
    v_cvt_pk_bf16_f32 v72, v48, v49
    v_mfma_f32_32x32x16_bf16 v[80:95], v[160:163], v[64:67], v[80:95]
    v_exp_f32 v52, v52
    v_exp_f32 v53, v53
    v_cvt_pk_bf16_f32 v73, v50, v51
    v_exp_f32 v54, v54
    v_exp_f32 v55, v55
    v_cvt_pk_bf16_f32 v74, v52, v53
    v_exp_f32 v56, v56
    v_exp_f32 v57, v57
    v_cvt_pk_bf16_f32 v75, v54, v55
    v_mfma_f32_32x32x16_bf16 v[80:95], v[164:167], v[68:71], v[80:95]
    v_exp_f32 v58, v58
    v_exp_f32 v59, v59
    v_cvt_pk_bf16_f32 v76, v56, v57
    v_exp_f32 v60, v60
    v_exp_f32 v61, v61
    v_cvt_pk_bf16_f32 v77, v58, v59
    v_exp_f32 v62, v62
    v_exp_f32 v63, v63
    v_cvt_pk_bf16_f32 v78, v60, v61
    v_cvt_pk_bf16_f32 v79, v62, v63
    v_add_u32 v4, 2048, v4
    v_add_u32 v5, 2048, v5
    s_add_u32 s34, s34, 1
    s_cmp_lt_u32 s34, 16
    s_cbranch_scc1 att_lean_49
    s_branch att_tail_39
att_slowloop_38:
    ds_read_b128 v[148:151], v4 offset:1024
    v_mfma_f32_32x32x16_bf16 v[48:63], v[144:147], v[12:15], v[128:143]
    s_nop 6
    v_exp_f32 v32, v32
    v_exp_f32 v33, v33
    v_exp_f32 v34, v34
    v_exp_f32 v35, v35
    v_cvt_pk_bf16_f32 v64, v32, v33
    v_mfma_f32_32x32x16_bf16 v[96:111], v[160:163], v[72:75], v[96:111]
    v_exp_f32 v36, v36
    v_exp_f32 v37, v37
    v_cvt_pk_bf16_f32 v65, v34, v35
    v_exp_f32 v38, v38
    v_exp_f32 v39, v39
    v_cvt_pk_bf16_f32 v66, v36, v37
    v_exp_f32 v40, v40
    v_exp_f32 v41, v41
    v_cvt_pk_bf16_f32 v67, v38, v39
    v_mfma_f32_32x32x16_bf16 v[96:111], v[164:167], v[76:79], v[96:111]
    v_exp_f32 v42, v42
    v_exp_f32 v43, v43
    v_cvt_pk_bf16_f32 v68, v40, v41
    v_exp_f32 v44, v44
    v_exp_f32 v45, v45
    v_cvt_pk_bf16_f32 v69, v42, v43
    v_exp_f32 v46, v46
    v_exp_f32 v47, v47
    v_cvt_pk_bf16_f32 v70, v44, v45
    v_cvt_pk_bf16_f32 v71, v46, v47
    s_mov_b64 exec, s[30:31]
    ds_read_b128 v[160:163], v5 offset:1024
    ds_read_b128 v[164:167], v5 offset:1536
    s_mov_b64 exec, -1
    s_waitcnt lgkmcnt(2)
    v_mov_b32 v19, s34
    ds_write_b32 v17, v19
    ds_read_b32 v24, v18
    v_mfma_f32_32x32x16_bf16 v[32:47], v[148:151], v[8:11], v[112:127]
    v_exp_f32 v48, v48
    v_exp_f32 v49, v49
    v_exp_f32 v50, v50
    v_exp_f32 v51, v51
    v_cvt_pk_bf16_f32 v72, v48, v49
    v_mfma_f32_32x32x16_bf16 v[80:95], v[152:155], v[64:67], v[80:95]
    v_exp_f32 v52, v52
    v_exp_f32 v53, v53
    v_cvt_pk_bf16_f32 v73, v50, v51
    v_exp_f32 v54, v54
    v_exp_f32 v55, v55
    v_cvt_pk_bf16_f32 v74, v52, v53
    v_exp_f32 v56, v56
    v_exp_f32 v57, v57
    v_cvt_pk_bf16_f32 v75, v54, v55
    v_mfma_f32_32x32x16_bf16 v[80:95], v[156:159], v[68:71], v[80:95]
    v_exp_f32 v58, v58
    v_exp_f32 v59, v59
    v_cvt_pk_bf16_f32 v76, v56, v57
    v_exp_f32 v60, v60
    v_exp_f32 v61, v61
    v_cvt_pk_bf16_f32 v77, v58, v59
    v_exp_f32 v62, v62
    v_exp_f32 v63, v63
    v_cvt_pk_bf16_f32 v78, v60, v61
    v_cvt_pk_bf16_f32 v79, v62, v63
    ds_read_b128 v[144:147], v4 offset:2048
    v_mfma_f32_32x32x16_bf16 v[48:63], v[148:151], v[12:15], v[128:143]
    v_exp_f32 v32, v32
    v_exp_f32 v33, v33
    v_exp_f32 v34, v34
    v_exp_f32 v35, v35
    v_cvt_pk_bf16_f32 v64, v32, v33
    v_mfma_f32_32x32x16_bf16 v[96:111], v[152:155], v[72:75], v[96:111]
    v_exp_f32 v36, v36
    v_exp_f32 v37, v37
    v_cvt_pk_bf16_f32 v65, v34, v35
    v_exp_f32 v38, v38
    v_exp_f32 v39, v39
    v_cvt_pk_bf16_f32 v66, v36, v37
    v_exp_f32 v40, v40
    v_exp_f32 v41, v41
    v_cvt_pk_bf16_f32 v67, v38, v39
    v_mfma_f32_32x32x16_bf16 v[96:111], v[156:159], v[76:79], v[96:111]
    v_exp_f32 v42, v42
    v_exp_f32 v43, v43
    v_cvt_pk_bf16_f32 v68, v40, v41
    v_exp_f32 v44, v44
    v_exp_f32 v45, v45
    v_cvt_pk_bf16_f32 v69, v42, v43
    v_exp_f32 v46, v46
    v_exp_f32 v47, v47
    v_cvt_pk_bf16_f32 v70, v44, v45
    v_cvt_pk_bf16_f32 v71, v46, v47
    s_mov_b64 exec, s[30:31]
    ds_read_b128 v[152:155], v5 offset:2048
    ds_read_b128 v[156:159], v5 offset:2560
    s_mov_b64 exec, -1
    s_waitcnt lgkmcnt(2)
    v_readfirstlane_b32 s20, v24
    s_nop 3
    s_cmp_gt_u32 s34, s20
    s_cselect_b32 s20, 0, 1
    s_cmp_eq_u32 s20, 1
    s_cbranch_scc1 att_hi_52
    s_setprio 0
    s_branch att_pd_53
att_hi_52:
    s_setprio 1
att_pd_53:
    v_mfma_f32_32x32x16_bf16 v[32:47], v[144:147], v[8:11], v[112:127]
    v_exp_f32 v48, v48
    v_exp_f32 v49, v49
    v_exp_f32 v50, v50
    v_exp_f32 v51, v51
    v_cvt_pk_bf16_f32 v72, v48, v49
    v_mfma_f32_32x32x16_bf16 v[80:95], v[160:163], v[64:67], v[80:95]
    v_exp_f32 v52, v52
    v_exp_f32 v53, v53
    v_cvt_pk_bf16_f32 v73, v50, v51
    v_exp_f32 v54, v54
    v_exp_f32 v55, v55
    v_cvt_pk_bf16_f32 v74, v52, v53
    v_exp_f32 v56, v56
    v_exp_f32 v57, v57
    v_cvt_pk_bf16_f32 v75, v54, v55
    v_mfma_f32_32x32x16_bf16 v[80:95], v[164:167], v[68:71], v[80:95]
    v_exp_f32 v58, v58
    v_exp_f32 v59, v59
    v_cvt_pk_bf16_f32 v76, v56, v57
    v_exp_f32 v60, v60
    v_exp_f32 v61, v61
    v_cvt_pk_bf16_f32 v77, v58, v59
    v_exp_f32 v62, v62
    v_exp_f32 v63, v63
    v_cvt_pk_bf16_f32 v78, v60, v61
    v_cvt_pk_bf16_f32 v79, v62, v63
    v_add_u32 v4, 2048, v4
    v_add_u32 v5, 2048, v5
    s_add_u32 s34, s34, 1
    s_cmp_lt_u32 s34, 16
    s_cbranch_scc1 att_slowloop_38
att_tail_39:
    v_mov_b32 v19, 64
    ds_write_b32 v17, v19
    s_setprio 0
    v_mfma_f32_32x32x16_bf16 v[96:111], v[160:163], v[72:75], v[96:111]
    v_mfma_f32_32x32x16_bf16 v[96:111], v[164:167], v[76:79], v[96:111]
    s_mul_i32 s20, s3, 2560
    s_add_u32 s20, s20, 131072
    v_add_u32 v6, s20, v2
    v_lshlrev_b32 v7, 2, v1
    v_add_u32 v7, s20, v7
    s_cmp_eq_u32 s7, 0
    s_cbranch_scc1 att_k1_54
    ds_write_b128 v6, v[80:83]
    ds_write_b128 v6, v[84:87] offset:1024
    ds_write_b32 v7, v88 offset:2048
    s_nop 1
    v_mov_b32 v80, v96
    v_mov_b32 v81, v97
    v_mov_b32 v82, v98
    v_mov_b32 v83, v99
    v_mov_b32 v84, v100
    v_mov_b32 v85, v101
    v_mov_b32 v86, v102
    v_mov_b32 v87, v103
    v_mov_b32 v88, v104
    s_branch att_x_55
att_k1_54:
    s_nop 4
    ds_write_b128 v6, v[96:99]
    ds_write_b128 v6, v[100:103] offset:1024
    ds_write_b32 v7, v104 offset:2048
att_x_55:
    s_xor_b32 s21, s3, 4
    s_mul_i32 s21, s21, 2560
    s_add_u32 s21, s21, 131072
    v_add_u32 v6, s21, v2
    v_lshlrev_b32 v7, 2, v1
    v_add_u32 v7, s21, v7
    s_waitcnt lgkmcnt(0)
    s_barrier
    ds_read_b128 v[32:35], v6
    ds_read_b128 v[36:39], v6 offset:1024
    ds_read_b32 v40, v7 offset:2048
    v_mov_b32 v20, 0x33800000
    v_mov_b32 v21, 0x53800000
    v_mov_b32 v22, 0x7f7fffff
    s_waitcnt lgkmcnt(0)
    v_add_f32 v80, v80, v32
    v_add_f32 v81, v81, v33
    v_add_f32 v82, v82, v34
    v_add_f32 v83, v83, v35
    v_add_f32 v84, v84, v36
    v_add_f32 v85, v85, v37
    v_add_f32 v86, v86, v38
    v_add_f32 v87, v87, v39
    v_add_f32 v88, v88, v40
    v_max3_f32 v23, |v80|, |v81|, |v82|
    v_max3_f32 v23, v23, |v83|, |v84|
    v_max3_f32 v23, v23, |v85|, |v86|
    v_max_f32 v23, v23, |v87|
    v_cmp_ge_f32 vcc, v88, v20
    v_cmp_le_f32 s[36:37], v88, v21
    v_cmp_le_f32 s[38:39], v23, v22
    s_nop 2
    s_and_b64 s[36:37], s[36:37], vcc
    s_and_b64 s[36:37], s[36:37], s[38:39]
    s_cmp_eq_u64 s[36:37], -1
    s_cbranch_scc1 att_ok_56
    v_mov_b32 v3, 151552
    v_mov_b32 v20, 1
    ds_write_b32 v3, v20
    s_waitcnt lgkmcnt(0)
att_ok_56:
    v_rcp_f32 v20, v88
    s_nop 0
    v_mul_f32 v80, v80, v20
    v_mul_f32 v81, v81, v20
    v_mul_f32 v82, v82, v20
    v_mul_f32 v83, v83, v20
    v_mul_f32 v84, v84, v20
    v_mul_f32 v85, v85, v20
    v_mul_f32 v86, v86, v20
    v_mul_f32 v87, v87, v20
    v_cvt_pk_bf16_f32 v48, v80, v81
    v_cvt_pk_bf16_f32 v49, v82, v83
    v_cvt_pk_bf16_f32 v50, v84, v85
    v_cvt_pk_bf16_f32 v51, v86, v87
    s_barrier
    v_mov_b32 v3, 151552
    ds_read_b32 v20, v3
    s_lshl_b32 s20, s57, 3
    s_lshl_b32 s21, s6, 1
    s_add_u32 s20, s20, s21
    s_add_u32 s20, s20, s7
    s_lshl_b32 s20, s20, 15
    s_lshl_b32 s21, s58, 10
    s_add_u32 s22, s20, s21
    s_waitcnt lgkmcnt(0)
    v_readfirstlane_b32 s20, v20
    s_cmp_lg_u32 s33, 0
    s_cbranch_scc1 att_fin_57
    s_nop 1
    s_cmp_lg_u32 s20, 0
    s_cbranch_scc1 att_slow_58
att_fin_57:
    buffer_store_dwordx4 v[48:51], v2, s[16:19], s22 offen sc1
    s_branch att_end_29
att_slow_58:
    s_mov_b32 s33, 8
    s_lshl_b32 s20, s7, 15
    v_add_u32 v4, s20, v2
    v_mov_b32 v20, 0xff800000
    v_mov_b32 v21, 0xff800000
    s_mov_b32 s34, 0
att_sl_59:
    ds_read_b128 v[144:147], v4 offset:0
    s_waitcnt lgkmcnt(0)
    v_mfma_f32_32x32x16_bf16 v[32:47], v[144:147], v[8:11], 0
    v_mfma_f32_32x32x16_bf16 v[48:63], v[144:147], v[12:15], 0
    s_nop 10
    v_max3_f32 v20, v20, v32, v33
    v_max3_f32 v20, v20, v34, v35
    v_max3_f32 v20, v20, v36, v37
    v_max3_f32 v20, v20, v38, v39
    v_max3_f32 v20, v20, v40, v41
    v_max3_f32 v20, v20, v42, v43
    v_max3_f32 v20, v20, v44, v45
    v_max3_f32 v20, v20, v46, v47
    v_max3_f32 v21, v21, v48, v49
    v_max3_f32 v21, v21, v50, v51
    v_max3_f32 v21, v21, v52, v53
    v_max3_f32 v21, v21, v54, v55
    v_max3_f32 v21, v21, v56, v57
    v_max3_f32 v21, v21, v58, v59
    v_max3_f32 v21, v21, v60, v61
    v_max3_f32 v21, v21, v62, v63
    v_add_u32 v4, 1024, v4
    s_add_u32 s34, s34, 1
    s_cmp_lt_u32 s34, 32
    s_cbranch_scc1 att_sl_59
    v_mov_b32 v22, v20
    s_nop 1
    v_permlane32_swap_b32 v20, v22
    v_max_f32 v20, v20, v22
    v_mov_b32 v22, v21
    s_nop 1
    v_permlane32_swap_b32 v21, v22
    v_max_f32 v21, v21, v22
    s_lshl_b32 s20, s3, 9
    s_add_u32 s20, s20, 131072
    v_lshlrev_b32 v6, 2, v1
    v_add_u32 v7, s20, v6
    s_barrier
    ds_write_b32 v7, v20
    ds_write_b32 v7, v21 offset:256
    s_waitcnt lgkmcnt(0)
    s_barrier
    s_xor_b32 s20, s3, 4
    s_lshl_b32 s20, s20, 9
    s_add_u32 s20, s20, 131072
    v_add_u32 v7, s20, v6
    ds_read_b32 v22, v7
    ds_read_b32 v23, v7 offset:256
    s_waitcnt lgkmcnt(0)
    v_max_f32 v20, v20, v22
    v_max_f32 v21, v21, v23
    v_sub_f32 v112, 0, v20
    v_sub_f32 v128, 0, v21
    v_sub_f32 v113, 0, v20
    v_sub_f32 v129, 0, v21
    v_sub_f32 v114, 0, v20
    v_sub_f32 v130, 0, v21
    v_sub_f32 v115, 0, v20
    v_sub_f32 v131, 0, v21
    v_sub_f32 v116, 0, v20
    v_sub_f32 v132, 0, v21
    v_sub_f32 v117, 0, v20
    v_sub_f32 v133, 0, v21
    v_sub_f32 v118, 0, v20
    v_sub_f32 v134, 0, v21
    v_sub_f32 v119, 0, v20
    v_sub_f32 v135, 0, v21
    v_sub_f32 v120, 0, v20
    v_sub_f32 v136, 0, v21
    v_sub_f32 v121, 0, v20
    v_sub_f32 v137, 0, v21
    v_sub_f32 v122, 0, v20
    v_sub_f32 v138, 0, v21
    v_sub_f32 v123, 0, v20
    v_sub_f32 v139, 0, v21
    v_sub_f32 v124, 0, v20
    v_sub_f32 v140, 0, v21
    v_sub_f32 v125, 0, v20
    v_sub_f32 v141, 0, v21
    v_sub_f32 v126, 0, v20
    v_sub_f32 v142, 0, v21
    v_sub_f32 v127, 0, v20
    v_sub_f32 v143, 0, v21
    s_barrier
    s_branch att_restart_37
att_end_29:
    s_waitcnt vmcnt(0) lgkmcnt(0)
    s_barrier
    s_cmp_lg_u32 s3, 7
    s_cbranch_scc1 sig_60
    s_lshl_b32 s46, s57, 7
    s_lshl_b32 s47, s58, 2
    s_add_u32 s46, s46, s47
    s_add_u32 s46, s46, 16384
    v_mov_b32 v250, s59
    v_mul_u32_u24 v251, 1, v1
    s_mov_b64 exec, 1
    buffer_store_dword v250, v251, s[60:63], s46 offen sc1
    s_mov_b64 exec, -1
sig_60:
    s_add_u32 s8, s88, 0x700000
    s_addc_u32 s9, s89, 0
    s_mov_b32 s10, 0x200000
    s_mov_b32 s11, 0x20000
    s_mov_b32 s12, s68
    s_mov_b32 s13, s69
    s_mov_b32 s14, 0x80000
    s_mov_b32 s15, 0x20000
    s_mov_b32 s16, s64
    s_mov_b32 s17, s65
    s_mov_b32 s18, 0x200000
    s_mov_b32 s19, 0x20000
    s_add_u32 s24, s88, 0x900000
    s_addc_u32 s25, s89, 0
    s_mov_b32 s26, 0x200000
    s_mov_b32 s27, 0x20000
    s_mov_b32 s28, s88
    s_mov_b32 s29, s89
    s_mov_b32 s30, 0xc000
    s_mov_b32 s31, 0x20000
    v_lshlrev_b32 v2, 4, v1
    v_lshrrev_b32 v3, 3, v1
    v_and_b32 v4, 7, v1
    v_bfe_u32 v5, v3, 1, 1
    v_lshlrev_b32 v5, 2, v5
    v_xor_b32 v4, v4, v5
    v_lshlrev_b32 v3, 10, v3
    v_lshl_add_u32 v3, v4, 4, v3
    s_lshl_b32 s20, s5, 7
    v_add_u32 v3, s20, v3
    s_and_b32 s20, s3, 1
    s_lshl_b32 s20, s20, 13
    s_lshr_b32 s21, s3, 2
    s_lshl_b32 s22, s21, 12
    s_add_u32 s20, s20, s22
    s_add_u32 s20, s20, 65536
    v_add_u32 v8, s20, v2
    v_lshrrev_b32 v4, 4, v1
    v_and_b32 v5, 15, v1
    v_lshrrev_b32 v6, 2, v5
    v_and_b32 v7, 3, v5
    v_lshrrev_b32 v10, 1, v4
    v_and_b32 v11, 1, v4
    v_lshl_add_u32 v12, v10, 2, v6
    v_lshlrev_b32 v12, 7, v12
    v_bfe_u32 v13, v6, 1, 1
    s_bfe_u32 s20, s3, 0x10001
    v_xor_b32 v13, s20, v13
    v_lshl_add_u32 v12, v13, 6, v12
    v_lshl_add_u32 v12, v11, 5, v12
    v_lshl_add_u32 v12, v7, 3, v12
    s_lshl_b32 s22, s21, 13
    s_add_u32 s22, s22, 0
    v_add_u32 v9, s22, v12
    v_lshrrev_b32 v14, 2, v1
    v_and_b32 v15, 3, v1
    s_and_b32 s20, s3, 1
    s_lshl_b32 s20, s20, 5
    s_lshl_b32 s21, s4, 6
    s_add_u32 s20, s20, s21
    s_lshr_b32 s21, s3, 2
    s_lshl_b32 s21, s21, 4
    s_add_u32 s36, s20, s21
    v_add_u32 v16, s36, v14
    v_lshlrev_b32 v16, 10, v16
    v_lshl_add_u32 v16, v15, 4, v16
    s_bfe_u32 s20, s3, 0x10001
    s_lshl_b32 s20, s20, 6
    s_lshl_b32 s21, s5, 7
    s_add_u32 s32, s20, s21
    v_lshlrev_b32 v17, 5, v15
    s_lshl_b32 s33, s32, 1
    s_cmp_eq_u32 s3, 7
    s_cbranch_scc1 wf7_62
    s_add_u32 s21, s3, 0
    s_lshl_b32 s20, s21, 13
    s_lshl_b32 s21, s21, 10
    s_mov_b32 m0, s21
    s_nop 0
    buffer_load_dwordx4 v3, s[12:15], s20 offen lds
    s_add_u32 s21, s3, 7
    s_lshl_b32 s20, s21, 13
    s_lshl_b32 s21, s21, 10
    s_mov_b32 m0, s21
    s_nop 0
    buffer_load_dwordx4 v3, s[12:15], s20 offen lds
    s_add_u32 s21, s3, 14
    s_lshl_b32 s20, s21, 13
    s_lshl_b32 s21, s21, 10
    s_mov_b32 m0, s21
    s_nop 0
    buffer_load_dwordx4 v3, s[12:15], s20 offen lds
    s_add_u32 s21, s3, 21
    s_lshl_b32 s20, s21, 13
    s_lshl_b32 s21, s21, 10
    s_mov_b32 m0, s21
    s_nop 0
    buffer_load_dwordx4 v3, s[12:15], s20 offen lds
    s_add_u32 s21, s3, 28
    s_lshl_b32 s20, s21, 13
    s_lshl_b32 s21, s21, 10
    s_mov_b32 m0, s21
    s_nop 0
    buffer_load_dwordx4 v3, s[12:15], s20 offen lds
    s_add_u32 s21, s3, 35
    s_lshl_b32 s20, s21, 13
    s_lshl_b32 s21, s21, 10
    s_mov_b32 m0, s21
    s_nop 0
    buffer_load_dwordx4 v3, s[12:15], s20 offen lds
    s_add_u32 s21, s3, 42
    s_lshl_b32 s20, s21, 13
    s_lshl_b32 s21, s21, 10
    s_mov_b32 m0, s21
    s_nop 0
    buffer_load_dwordx4 v3, s[12:15], s20 offen lds
    s_add_u32 s21, s3, 49
    s_lshl_b32 s20, s21, 13
    s_lshl_b32 s21, s21, 10
    s_mov_b32 m0, s21
    s_nop 0
    buffer_load_dwordx4 v3, s[12:15], s20 offen lds
    s_add_u32 s21, s3, 56
    s_lshl_b32 s20, s21, 13
    s_lshl_b32 s21, s21, 10
    s_mov_b32 m0, s21
    s_nop 0
    buffer_load_dwordx4 v3, s[12:15], s20 offen lds
    s_cmp_lg_u32 s3, 0
    s_cbranch_scc1 p3w_63
    s_add_u32 s21, s3, 63
    s_lshl_b32 s20, s21, 13
    s_lshl_b32 s21, s21, 10
    s_mov_b32 m0, s21
    s_nop 0
    buffer_load_dwordx4 v3, s[12:15], s20 offen lds
p3w_63:
    s_branch wf_61
wf7_62:
    s_and_b32 s46, s2, 7
    s_lshl_b32 s46, s46, 10
    s_add_u32 s46, s46, 256
    v_lshlrev_b32 v251, 2, v1
    s_mov_b32 s42, 0xffffffff
    s_mov_b32 s43, 0xffffffff
    s_mov_b32 s47, 0
poll_64:
    buffer_load_dword v250, v251, s[60:63], s46 offen sc0 sc1
    s_add_u32 s47, s47, 1
    s_cmp_gt_u32 s47, 1048576
    s_cbranch_scc1 polled_65
    s_waitcnt vmcnt(0)
    v_cmp_eq_u32 vcc, s59, v250
    s_nop 3
    s_and_b64 vcc, vcc, s[42:43]
    s_cmp_eq_u64 vcc, s[42:43]
    s_cbranch_scc0 poll_64
polled_65:
    s_and_b32 s46, s2, 7
    s_lshl_b32 s46, s46, 10
    s_add_u32 s46, s46, 512
    v_lshlrev_b32 v251, 2, v1
    s_mov_b32 s42, 0xffffffff
    s_mov_b32 s43, 0xffffffff
    s_mov_b32 s47, 0
poll_66:
    buffer_load_dword v250, v251, s[60:63], s46 offen sc0 sc1
    s_add_u32 s47, s47, 1
    s_cmp_gt_u32 s47, 1048576
    s_cbranch_scc1 polled_67
    s_waitcnt vmcnt(0)
    v_cmp_eq_u32 vcc, s59, v250
    s_nop 3
    s_and_b64 vcc, vcc, s[42:43]
    s_cmp_eq_u64 vcc, s[42:43]
    s_cbranch_scc0 poll_66
polled_67:
    s_lshr_b32 s46, s4, 2
    s_lshl_b32 s46, s46, 7
    s_add_u32 s46, s46, 16384
    v_lshlrev_b32 v251, 2, v1
    s_mov_b32 s42, 0xffffffff
    s_mov_b32 s43, 0x0
    s_mov_b32 s47, 0
poll_68:
    buffer_load_dword v250, v251, s[60:63], s46 offen sc0 sc1
    s_add_u32 s47, s47, 1
    s_cmp_gt_u32 s47, 1048576
    s_cbranch_scc1 polled_69
    s_waitcnt vmcnt(0)
    v_cmp_eq_u32 vcc, s59, v250
    s_nop 3
    s_and_b64 vcc, vcc, s[42:43]
    s_cmp_eq_u64 vcc, s[42:43]
    s_cbranch_scc0 poll_68
polled_69:
wf_61:
    s_barrier
    s_mul_i32 s6, s4, 65536
    s_lshl_b32 s21, s3, 10
    s_add_u32 s6, s6, s21
    s_add_u32 s20, s6, 0
    s_add_u32 m0, s21, 65536
    s_nop 0
    buffer_load_dwordx4 v2, s[8:11], s20 offen lds
    s_add_u32 s20, s6, 32768
    s_add_u32 m0, s21, 73728
    s_nop 0
    buffer_load_dwordx4 v2, s[8:11], s20 offen lds
    s_barrier
    s_add_u32 s20, s6, 8192
    s_add_u32 m0, s21, 81920
    s_nop 0
    buffer_load_dwordx4 v2, s[8:11], s20 offen lds
    s_add_u32 s20, s6, 40960
    s_add_u32 m0, s21, 90112
    s_nop 0
    buffer_load_dwordx4 v2, s[8:11], s20 offen lds
    s_barrier
    s_add_u32 s20, s6, 16384
    s_add_u32 m0, s21, 98304
    s_nop 0
    buffer_load_dwordx4 v2, s[8:11], s20 offen lds
    s_add_u32 s20, s6, 49152
    s_add_u32 m0, s21, 106496
    s_nop 0
    buffer_load_dwordx4 v2, s[8:11], s20 offen lds
    s_barrier
    s_add_u32 s20, s6, 24576
    s_add_u32 m0, s21, 114688
    s_nop 0
    buffer_load_dwordx4 v2, s[8:11], s20 offen lds
    s_add_u32 s20, s6, 57344
    s_add_u32 m0, s21, 122880
    s_nop 0
    buffer_load_dwordx4 v2, s[8:11], s20 offen lds
    buffer_load_dwordx4 v[32:35], v16, s[16:19], s32 offen
    s_add_u32 s20, s33, 4096
    buffer_load_dwordx4 v[160:163], v17, s[28:31], s20 offen offset:0
    buffer_load_dwordx4 v[164:167], v17, s[28:31], s20 offen offset:16
    s_add_u32 s20, s33, 16384
    buffer_load_dwordx4 v[168:171], v17, s[28:31], s20 offen offset:0
    buffer_load_dwordx4 v[172:175], v17, s[28:31], s20 offen offset:16
    s_add_u32 s20, s33, 28672
    buffer_load_dwordx4 v[176:179], v17, s[28:31], s20 offen offset:0
    buffer_load_dwordx4 v[180:183], v17, s[28:31], s20 offen offset:16
    s_add_u32 s20, s33, 40960
    buffer_load_dwordx4 v[184:187], v17, s[28:31], s20 offen offset:0
    buffer_load_dwordx4 v[188:191], v17, s[28:31], s20 offen offset:16
    v_mov_b32 v64, 0
    v_mov_b32 v65, 0
    v_mov_b32 v66, 0
    v_mov_b32 v67, 0
    v_mov_b32 v68, 0
    v_mov_b32 v69, 0
    v_mov_b32 v70, 0
    v_mov_b32 v71, 0
    v_mov_b32 v72, 0
    v_mov_b32 v73, 0
    v_mov_b32 v74, 0
    v_mov_b32 v75, 0
    v_mov_b32 v76, 0
    v_mov_b32 v77, 0
    v_mov_b32 v78, 0
    v_mov_b32 v79, 0
    s_waitcnt vmcnt(15)
    s_barrier
    ds_read_b128 v[96:99], v8 offset:0
    ds_read_b64_tr_b16 v[100:101], v9 offset:0
    ds_read_b64_tr_b16 v[102:103], v9 offset:1024
    ds_read_b128 v[104:107], v8 offset:1024
    ds_read_b64_tr_b16 v[108:109], v9 offset:2048
    ds_read_b64_tr_b16 v[110:111], v9 offset:3072
    ds_read_b128 v[112:115], v8 offset:2048
    ds_read_b64_tr_b16 v[116:117], v9 offset:4096
    ds_read_b64_tr_b16 v[118:119], v9 offset:5120
    ds_read_b128 v[120:123], v8 offset:3072
    ds_read_b64_tr_b16 v[124:125], v9 offset:6144
    ds_read_b64_tr_b16 v[126:127], v9 offset:7168
    s_waitcnt lgkmcnt(9)
    v_mfma_f32_32x32x16_bf16 v[64:79], v[100:103], v[96:99], v[64:79]
    s_waitcnt lgkmcnt(6)
    v_mfma_f32_32x32x16_bf16 v[64:79], v[108:111], v[104:107], v[64:79]
    s_waitcnt lgkmcnt(3)
    v_mfma_f32_32x32x16_bf16 v[64:79], v[116:119], v[112:115], v[64:79]
    s_waitcnt lgkmcnt(0)
    v_mfma_f32_32x32x16_bf16 v[64:79], v[124:127], v[120:123], v[64:79]
    s_waitcnt vmcnt(13)
    s_barrier
    ds_read_b128 v[96:99], v8 offset:16384
    ds_read_b64_tr_b16 v[100:101], v9 offset:16384
    ds_read_b64_tr_b16 v[102:103], v9 offset:17408
    ds_read_b128 v[104:107], v8 offset:17408
    ds_read_b64_tr_b16 v[108:109], v9 offset:18432
    ds_read_b64_tr_b16 v[110:111], v9 offset:19456
    ds_read_b128 v[112:115], v8 offset:18432
    ds_read_b64_tr_b16 v[116:117], v9 offset:20480
    ds_read_b64_tr_b16 v[118:119], v9 offset:21504
    ds_read_b128 v[120:123], v8 offset:19456
    ds_read_b64_tr_b16 v[124:125], v9 offset:22528
    ds_read_b64_tr_b16 v[126:127], v9 offset:23552
    s_waitcnt lgkmcnt(9)
    v_mfma_f32_32x32x16_bf16 v[64:79], v[100:103], v[96:99], v[64:79]
    s_waitcnt lgkmcnt(6)
    v_mfma_f32_32x32x16_bf16 v[64:79], v[108:111], v[104:107], v[64:79]
    s_waitcnt lgkmcnt(3)
    v_mfma_f32_32x32x16_bf16 v[64:79], v[116:119], v[112:115], v[64:79]
    s_waitcnt lgkmcnt(0)
    v_mfma_f32_32x32x16_bf16 v[64:79], v[124:127], v[120:123], v[64:79]
    s_waitcnt vmcnt(11)
    s_barrier
    ds_read_b128 v[96:99], v8 offset:32768
    ds_read_b64_tr_b16 v[100:101], v9 offset:32768
    ds_read_b64_tr_b16 v[102:103], v9 offset:33792
    ds_read_b128 v[104:107], v8 offset:33792
    ds_read_b64_tr_b16 v[108:109], v9 offset:34816
    ds_read_b64_tr_b16 v[110:111], v9 offset:35840
    ds_read_b128 v[112:115], v8 offset:34816
    ds_read_b64_tr_b16 v[116:117], v9 offset:36864
    ds_read_b64_tr_b16 v[118:119], v9 offset:37888
    ds_read_b128 v[120:123], v8 offset:35840
    ds_read_b64_tr_b16 v[124:125], v9 offset:38912
    ds_read_b64_tr_b16 v[126:127], v9 offset:39936
    s_waitcnt lgkmcnt(9)
    v_mfma_f32_32x32x16_bf16 v[64:79], v[100:103], v[96:99], v[64:79]
    s_waitcnt lgkmcnt(6)
    v_mfma_f32_32x32x16_bf16 v[64:79], v[108:111], v[104:107], v[64:79]
    s_waitcnt lgkmcnt(3)
    v_mfma_f32_32x32x16_bf16 v[64:79], v[116:119], v[112:115], v[64:79]
    s_waitcnt lgkmcnt(0)
    v_mfma_f32_32x32x16_bf16 v[64:79], v[124:127], v[120:123], v[64:79]
    s_waitcnt vmcnt(9)
    s_barrier
    ds_read_b128 v[96:99], v8 offset:49152
    ds_read_b64_tr_b16 v[100:101], v9 offset:49152
    ds_read_b64_tr_b16 v[102:103], v9 offset:50176
    ds_read_b128 v[104:107], v8 offset:50176
    ds_read_b64_tr_b16 v[108:109], v9 offset:51200
    ds_read_b64_tr_b16 v[110:111], v9 offset:52224
    ds_read_b128 v[112:115], v8 offset:51200
    ds_read_b64_tr_b16 v[116:117], v9 offset:53248
    ds_read_b64_tr_b16 v[118:119], v9 offset:54272
    ds_read_b128 v[120:123], v8 offset:52224
    ds_read_b64_tr_b16 v[124:125], v9 offset:55296
    ds_read_b64_tr_b16 v[126:127], v9 offset:56320
    s_waitcnt lgkmcnt(9)
    v_mfma_f32_32x32x16_bf16 v[64:79], v[100:103], v[96:99], v[64:79]
    s_waitcnt lgkmcnt(6)
    v_mfma_f32_32x32x16_bf16 v[64:79], v[108:111], v[104:107], v[64:79]
    s_waitcnt lgkmcnt(3)
    v_mfma_f32_32x32x16_bf16 v[64:79], v[116:119], v[112:115], v[64:79]
    s_waitcnt lgkmcnt(0)
    v_mfma_f32_32x32x16_bf16 v[64:79], v[124:127], v[120:123], v[64:79]
    s_barrier
    s_mul_i32 s20, s3, 4608
    v_and_b32 v18, 31, v1
    v_mul_u32_u24 v18, 144, v18
    v_lshrrev_b32 v19, 5, v1
    v_lshl_add_u32 v18, v19, 4, v18
    v_add_u32 v18, s20, v18
    s_nop 4
    ds_write_b128 v18, v[64:67] offset:0
    ds_write_b128 v18, v[68:71] offset:32
    ds_write_b128 v18, v[72:75] offset:64
    ds_write_b128 v18, v[76:79] offset:96
    s_waitcnt vmcnt(0)
    v_pk_add_f32 v[160:161], v[160:161], v[168:169]
    v_pk_add_f32 v[176:177], v[176:177], v[184:185]
    v_pk_add_f32 v[162:163], v[162:163], v[170:171]
    v_pk_add_f32 v[178:179], v[178:179], v[186:187]
    v_pk_add_f32 v[164:165], v[164:165], v[172:173]
    v_pk_add_f32 v[180:181], v[180:181], v[188:189]
    v_pk_add_f32 v[166:167], v[166:167], v[174:175]
    v_pk_add_f32 v[182:183], v[182:183], v[190:191]
    v_pk_add_f32 v[160:161], v[160:161], v[176:177]
    v_pk_add_f32 v[162:163], v[162:163], v[178:179]
    v_pk_add_f32 v[164:165], v[164:165], v[180:181]
    v_pk_add_f32 v[166:167], v[166:167], v[182:183]
    v_cvt_pk_bf16_f32 v168, v160, v161
    v_cvt_pk_bf16_f32 v169, v162, v163
    v_cvt_pk_bf16_f32 v170, v164, v165
    v_cvt_pk_bf16_f32 v171, v166, v167
    v_lshlrev_b32 v160, 16, v168
    v_and_b32 v161, 0xffff0000, v168
    v_lshlrev_b32 v162, 16, v169
    v_and_b32 v163, 0xffff0000, v169
    v_lshlrev_b32 v164, 16, v170
    v_and_b32 v165, 0xffff0000, v170
    v_lshlrev_b32 v166, 16, v171
    v_and_b32 v167, 0xffff0000, v171
    s_and_b32 s20, s3, 3
    s_mul_i32 s20, s20, 4608
    s_lshr_b32 s21, s3, 2
    s_mul_i32 s21, s21, 2304
    s_add_u32 s20, s20, s21
    v_mul_u32_u24 v18, 144, v14
    v_lshl_add_u32 v18, v15, 5, v18
    v_add_u32 v18, s20, v18
    s_waitcnt lgkmcnt(0)
    s_barrier
    ds_read_b128 v[48:51], v18
    ds_read_b128 v[52:55], v18 offset:16
    ds_read_b128 v[56:59], v18 offset:18432
    ds_read_b128 v[60:63], v18 offset:18448
    s_waitcnt lgkmcnt(0)
    v_pk_add_f32 v[48:49], v[48:49], v[56:57]
    v_pk_add_f32 v[50:51], v[50:51], v[58:59]
    v_pk_add_f32 v[52:53], v[52:53], v[60:61]
    v_pk_add_f32 v[54:55], v[54:55], v[62:63]
    v_lshlrev_b32 v56, 16, v32
    v_and_b32 v57, 0xffff0000, v32
    v_lshlrev_b32 v58, 16, v33
    v_and_b32 v59, 0xffff0000, v33
    v_lshlrev_b32 v60, 16, v34
    v_and_b32 v61, 0xffff0000, v34
    v_lshlrev_b32 v62, 16, v35
    v_and_b32 v63, 0xffff0000, v35
    v_pk_fma_f32 v[56:57], v[160:161], v[48:49], v[56:57]
    v_pk_fma_f32 v[58:59], v[162:163], v[50:51], v[58:59]
    v_pk_fma_f32 v[60:61], v[164:165], v[52:53], v[60:61]
    v_pk_fma_f32 v[62:63], v[166:167], v[54:55], v[62:63]
    v_cvt_pk_bf16_f32 v32, v56, v57
    v_cvt_pk_bf16_f32 v33, v58, v59
    v_cvt_pk_bf16_f32 v34, v60, v61
    v_cvt_pk_bf16_f32 v35, v62, v63
    buffer_store_dwordx4 v[32:35], v16, s[24:27], s32 offen sc1
    v_pk_add_f32 v[48:49], v[56:57], v[58:59]
    v_pk_add_f32 v[50:51], v[60:61], v[62:63]
    v_pk_add_f32 v[48:49], v[48:49], v[50:51]
    v_add_f32 v48, v48, v49
    s_nop 1
    v_add_f32_dpp v48, v48, v48 quad_perm:[1,0,3,2] row_mask:0xf bank_mask:0xf
    s_nop 1
    v_add_f32_dpp v48, v48, v48 quad_perm:[2,3,0,1] row_mask:0xf bank_mask:0xf
    v_mul_f32 v48, 0x3d000000, v48
    v_sub_f32 v50, 0, v48
    v_mov_b32 v51, v50
    v_pk_add_f32 v[56:57], v[56:57], v[50:51]
    v_pk_add_f32 v[58:59], v[58:59], v[50:51]
    v_pk_add_f32 v[60:61], v[60:61], v[50:51]
    v_pk_add_f32 v[62:63], v[62:63], v[50:51]
    v_pk_mul_f32 v[52:53], v[56:57], v[56:57]
    v_pk_fma_f32 v[52:53], v[58:59], v[58:59], v[52:53]
    v_pk_fma_f32 v[52:53], v[60:61], v[60:61], v[52:53]
    v_pk_fma_f32 v[52:53], v[62:63], v[62:63], v[52:53]
    v_add_f32 v49, v52, v53
    s_nop 1
    v_add_f32_dpp v49, v49, v49 quad_perm:[1,0,3,2] row_mask:0xf bank_mask:0xf
    s_nop 1
    v_add_f32_dpp v49, v49, v49 quad_perm:[2,3,0,1] row_mask:0xf bank_mask:0xf
    s_add_u32 s40, s88, 0x70000
    s_addc_u32 s41, s89, 0
    s_mov_b32 s42, 0x40000
    s_mov_b32 s43, 0x20000
    v_add_u32 v18, s36, v14
    v_lshlrev_b32 v18, 7, v18
    s_bfe_u32 s20, s3, 0x10001
    s_lshl_b32 s21, s5, 1
    s_add_u32 s20, s20, s21
    s_lshl_b32 s20, s20, 3
    v_cmp_eq_u32 vcc, 0, v15
    s_nop 3
    s_and_saveexec_b64 s[44:45], vcc
    buffer_store_dwordx2 v[48:49], v18, s[40:43], s20 offen sc1
    s_mov_b64 exec, s[44:45]
    s_waitcnt vmcnt(0) lgkmcnt(0)
    s_barrier
    s_cmp_lg_u32 s3, 7
    s_cbranch_scc1 sig_70
    s_lshl_b32 s46, s4, 7
    s_lshl_b32 s47, s5, 2
    s_add_u32 s46, s46, s47
    s_add_u32 s46, s46, 20480
    v_mov_b32 v250, s59
    v_mul_u32_u24 v251, 1, v1
    s_mov_b64 exec, 1
    buffer_store_dword v250, v251, s[60:63], s46 offen sc1
    s_mov_b64 exec, -1
sig_70:
    s_add_u32 s8, s88, 0x900000
    s_addc_u32 s9, s89, 0
    s_mov_b32 s10, 0x200000
    s_mov_b32 s11, 0x20000
    s_mov_b32 s12, s88
    s_mov_b32 s13, s89
    s_mov_b32 s14, 0xc000
    s_mov_b32 s15, 0x20000
    s_mov_b32 s16, s72
    s_mov_b32 s17, s73
    s_mov_b32 s18, 0x1c0000
    s_mov_b32 s19, 0x20000
    s_add_u32 s28, s88, 0x1300000
    s_addc_u32 s29, s89, 0
    s_mov_b32 s30, 0x380000
    s_mov_b32 s31, 0x20000
    s_add_u32 s36, s88, 0x10000
    s_addc_u32 s37, s89, 0
    s_mov_b32 s38, 0x40000
    s_mov_b32 s39, 0x20000
    s_lshl_b32 s20, s3, 6
    s_add_u32 s20, s20, 0
    v_add_u32 v200, s20, v1
    v_mul_u32_u24 v201, 4682, v200
    v_lshrrev_b32 v201, 16, v201
    v_mul_u32_u24 v202, 14, v201
    v_sub_u32 v202, v200, v202
    v_lshrrev_b32 v203, 1, v202
    v_xor_b32 v204, 4, v203
    v_cmp_eq_u32 vcc, 3, v203
    s_nop 1
    v_cndmask_b32 v204, v204, v203, vcc
    v_bfe_u32 v205, v201, 3, 1
    v_cmp_eq_u32 vcc, 1, v205
    s_nop 1
    v_cndmask_b32 v203, v203, v204, vcc
    v_and_b32 v202, 1, v202
    v_lshl_or_b32 v202, v203, 1, v202
    v_mul_u32_u24 v201, 3584, v201
    v_lshl_add_u32 v192, v202, 4, v201
    s_lshl_b32 s20, s3, 6
    s_add_u32 s20, s20, 512
    v_add_u32 v200, s20, v1
    v_mul_u32_u24 v201, 4682, v200
    v_lshrrev_b32 v201, 16, v201
    v_mul_u32_u24 v202, 14, v201
    v_sub_u32 v202, v200, v202
    v_lshrrev_b32 v203, 1, v202
    v_xor_b32 v204, 4, v203
    v_cmp_eq_u32 vcc, 3, v203
    s_nop 1
    v_cndmask_b32 v204, v204, v203, vcc
    v_bfe_u32 v205, v201, 3, 1
    v_cmp_eq_u32 vcc, 1, v205
    s_nop 1
    v_cndmask_b32 v203, v203, v204, vcc
    v_and_b32 v202, 1, v202
    v_lshl_or_b32 v202, v203, 1, v202
    v_mul_u32_u24 v201, 3584, v201
    v_lshl_add_u32 v193, v202, 4, v201
    s_lshl_b32 s7, s3, 10
    s_add_u32 s7, s7, 65536
    s_cmp_ge_u32 s3, 6
    s_cselect_b64 vcc, -1, 0
    v_cndmask_b32 v194, v193, v192, vcc
    s_cselect_b32 s35, 0, 8192
    s_add_u32 s35, s35, s7
    s_mul_i32 s33, s5, 224
    s_add_u32 s34, s33, 1792
    v_lshrrev_b32 v3, 4, v1
    v_and_b32 v4, 15, v1
    v_lshrrev_b32 v5, 2, v4
    v_and_b32 v6, 3, v4
    v_lshl_add_u32 v7, v3, 3, v5
    v_mul_u32_u24 v7, 224, v7
    v_lshl_add_u32 v7, v6, 3, v7
    v_add_u32 v7, 65536, v7
    v_and_b32 v8, 1, v3
    v_cmp_eq_u32 vcc, 1, v8
    s_lshr_b32 s20, s3, 1
    s_lshl_b32 s21, s20, 1
    s_add_u32 s21, s21, 0
    s_xor_b32 s22, s21, 4
    s_cmp_eq_u32 s21, 3
    s_cselect_b32 s22, s21, s22
    v_mov_b32 v9, s21
    v_mov_b32 v10, s22
    v_cndmask_b32 v9, v9, v10, vcc
    v_lshl_add_u32 v200, v9, 5, v7
    v_add_u32 v202, 57344, v200
    s_lshl_b32 s21, s20, 1
    s_add_u32 s21, s21, 1
    s_xor_b32 s22, s21, 4
    s_cmp_eq_u32 s21, 3
    s_cselect_b32 s22, s21, s22
    v_mov_b32 v9, s21
    v_mov_b32 v10, s22
    v_cndmask_b32 v9, v9, v10, vcc
    v_lshl_add_u32 v201, v9, 5, v7
    v_add_u32 v203, 57344, v201
    s_and_b32 s21, s3, 1
    s_lshl_b32 s21, s21, 5
    v_add_u32 v9, s21, v4
    v_lshlrev_b32 v9, 10, v9
    v_add_u32 v10, 0, v3
    v_xor_b32 v10, v10, v4
    v_lshl_add_u32 v208, v10, 4, v9
    v_add_u32 v10, 4, v3
    v_xor_b32 v10, v10, v4
    v_lshl_add_u32 v209, v10, 4, v9
    v_add_u32 v10, 8, v3
    v_xor_b32 v10, v10, v4
    v_lshl_add_u32 v210, v10, 4, v9
    v_add_u32 v10, 12, v3
    v_xor_b32 v10, v10, v4
    v_lshl_add_u32 v211, v10, 4, v9
    s_cmp_eq_u32 s3, 7
    s_cbranch_scc1 wf7_72
    v_lshlrev_b32 v248, 3, v0
    s_mov_b32 s22, 6144
    buffer_load_dwordx2 v[240:241], v248, s[12:15], s22 offen
    s_mov_b32 s22, 18432
    buffer_load_dwordx2 v[242:243], v248, s[12:15], s22 offen
    s_mov_b32 s22, 30720
    buffer_load_dwordx2 v[244:245], v248, s[12:15], s22 offen
    s_mov_b32 s22, 43008
    buffer_load_dwordx2 v[246:247], v248, s[12:15], s22 offen
    s_add_u32 s23, s34, 0
    s_add_u32 m0, s7, 0
    s_nop 0
    buffer_load_dwordx4 v192, s[16:19], s23 offen lds
    s_add_u32 m0, s35, 0
    s_nop 0
    buffer_load_dwordx4 v194, s[16:19], s23 offen lds
    s_add_u32 s23, s34, 229376
    s_add_u32 m0, s7, 14336
    s_nop 0
    buffer_load_dwordx4 v192, s[16:19], s23 offen lds
    s_add_u32 m0, s35, 14336
    s_nop 0
    buffer_load_dwordx4 v194, s[16:19], s23 offen lds
    s_add_u32 s23, s34, 458752
    s_add_u32 m0, s7, 28672
    s_nop 0
    buffer_load_dwordx4 v192, s[16:19], s23 offen lds
    s_add_u32 m0, s35, 28672
    s_nop 0
    buffer_load_dwordx4 v194, s[16:19], s23 offen lds
    s_add_u32 s23, s34, 688128
    s_add_u32 m0, s7, 43008
    s_nop 0
    buffer_load_dwordx4 v192, s[16:19], s23 offen lds
    s_add_u32 m0, s35, 43008
    s_nop 0
    buffer_load_dwordx4 v194, s[16:19], s23 offen lds
    s_add_u32 s23, s34, 917504
    s_add_u32 m0, s7, 57344
    s_nop 0
    buffer_load_dwordx4 v192, s[16:19], s23 offen lds
    s_add_u32 m0, s35, 57344
    s_nop 0
    buffer_load_dwordx4 v194, s[16:19], s23 offen lds
    s_waitcnt vmcnt(10)
    v_pk_add_f32 v[240:241], v[240:241], v[242:243]
    v_pk_add_f32 v[244:245], v[244:245], v[246:247]
    v_pk_add_f32 v[240:241], v[240:241], v[244:245]
    v_cvt_pk_bf16_f32 v242, v240, v241
    v_lshlrev_b32 v240, 16, v242
    v_and_b32 v241, 0xffff0000, v242
    s_cmp_lt_u32 s3, 4
    s_cbranch_scc1 mf_73
    v_add_f32 v240, 1.0, v240
    v_add_f32 v241, 1.0, v241
    v_cvt_pk_bf16_f32 v242, v240, v241
    v_lshlrev_b32 v240, 16, v242
    v_and_b32 v241, 0xffff0000, v242
mf_73:
    v_and_b32 v242, 255, v0
    v_lshlrev_b32 v242, 1, v242
    v_lshrrev_b32 v243, 7, v242
    v_lshlrev_b32 v248, 9, v243
    v_bfe_u32 v243, v242, 2, 1
    v_lshl_add_u32 v248, v243, 8, v248
    v_bfe_u32 v243, v242, 3, 4
    v_lshl_add_u32 v248, v243, 4, v248
    v_and_b32 v243, 3, v242
    v_lshl_add_u32 v248, v243, 2, v248
    v_lshrrev_b32 v243, 8, v0
    v_lshl_add_u32 v248, v243, 11, v248
    v_add_u32 v248, 151552, v248
    ds_write_b64 v248, v[240:241]
    s_waitcnt lgkmcnt(0)
    s_branch wf_71
wf7_72:
    s_lshl_b32 s46, s4, 7
    s_add_u32 s46, s46, 20480
    v_lshlrev_b32 v251, 2, v1
    s_mov_b32 s42, 0xff
    s_mov_b32 s43, 0x0
    s_mov_b32 s47, 0
poll_74:
    buffer_load_dword v250, v251, s[60:63], s46 offen sc0 sc1
    s_add_u32 s47, s47, 1
    s_cmp_gt_u32 s47, 1048576
    s_cbranch_scc1 polled_75
    s_waitcnt vmcnt(0)
    v_cmp_eq_u32 vcc, s59, v250
    s_nop 3
    s_and_b64 vcc, vcc, s[42:43]
    s_cmp_eq_u64 vcc, s[42:43]
    s_cbranch_scc0 poll_74
polled_75:
    v_lshlrev_b32 v248, 3, v0
    s_mov_b32 s22, 6144
    buffer_load_dwordx2 v[240:241], v248, s[12:15], s22 offen
    s_mov_b32 s22, 18432
    buffer_load_dwordx2 v[242:243], v248, s[12:15], s22 offen
    s_mov_b32 s22, 30720
    buffer_load_dwordx2 v[244:245], v248, s[12:15], s22 offen
    s_mov_b32 s22, 43008
    buffer_load_dwordx2 v[246:247], v248, s[12:15], s22 offen
    s_add_u32 s23, s34, 0
    s_add_u32 m0, s7, 0
    s_nop 0
    buffer_load_dwordx4 v192, s[16:19], s23 offen lds
    s_add_u32 m0, s35, 0
    s_nop 0
    buffer_load_dwordx4 v194, s[16:19], s23 offen lds
    s_add_u32 s23, s34, 229376
    s_add_u32 m0, s7, 14336
    s_nop 0
    buffer_load_dwordx4 v192, s[16:19], s23 offen lds
    s_add_u32 m0, s35, 14336
    s_nop 0
    buffer_load_dwordx4 v194, s[16:19], s23 offen lds
    s_add_u32 s23, s34, 458752
    s_add_u32 m0, s7, 28672
    s_nop 0
    buffer_load_dwordx4 v192, s[16:19], s23 offen lds
    s_add_u32 m0, s35, 28672
    s_nop 0
    buffer_load_dwordx4 v194, s[16:19], s23 offen lds
    s_add_u32 s23, s34, 688128
    s_add_u32 m0, s7, 43008
    s_nop 0
    buffer_load_dwordx4 v192, s[16:19], s23 offen lds
    s_add_u32 m0, s35, 43008
    s_nop 0
    buffer_load_dwordx4 v194, s[16:19], s23 offen lds
    s_add_u32 s23, s34, 917504
    s_add_u32 m0, s7, 57344
    s_nop 0
    buffer_load_dwordx4 v192, s[16:19], s23 offen lds
    s_add_u32 m0, s35, 57344
    s_nop 0
    buffer_load_dwordx4 v194, s[16:19], s23 offen lds
    s_waitcnt vmcnt(10)
    v_pk_add_f32 v[240:241], v[240:241], v[242:243]
    v_pk_add_f32 v[244:245], v[244:245], v[246:247]
    v_pk_add_f32 v[240:241], v[240:241], v[244:245]
    v_cvt_pk_bf16_f32 v242, v240, v241
    v_lshlrev_b32 v240, 16, v242
    v_and_b32 v241, 0xffff0000, v242
    s_cmp_lt_u32 s3, 4
    s_cbranch_scc1 mf_76
    v_add_f32 v240, 1.0, v240
    v_add_f32 v241, 1.0, v241
    v_cvt_pk_bf16_f32 v242, v240, v241
    v_lshlrev_b32 v240, 16, v242
    v_and_b32 v241, 0xffff0000, v242
mf_76:
    v_and_b32 v242, 255, v0
    v_lshlrev_b32 v242, 1, v242
    v_lshrrev_b32 v243, 7, v242
    v_lshlrev_b32 v248, 9, v243
    v_bfe_u32 v243, v242, 2, 1
    v_lshl_add_u32 v248, v243, 8, v248
    v_bfe_u32 v243, v242, 3, 4
    v_lshl_add_u32 v248, v243, 4, v248
    v_and_b32 v243, 3, v242
    v_lshl_add_u32 v248, v243, 2, v248
    v_lshrrev_b32 v243, 8, v0
    v_lshl_add_u32 v248, v243, 11, v248
    v_add_u32 v248, 151552, v248
    ds_write_b64 v248, v[240:241]
    s_waitcnt lgkmcnt(0)
wf_71:
    s_barrier
    s_lshl_b32 s6, s4, 16
    v_lshrrev_b32 v3, 4, v1
    v_and_b32 v4, 15, v1
    s_lshl_b32 s20, s3, 3
    v_add_u32 v5, s20, v3
    v_lshlrev_b32 v5, 10, v5
    v_lshl_add_u32 v5, v4, 4, v5
    s_add_u32 s21, s6, 4096
    buffer_load_dwordx4 v[32:35], v5, s[8:11], s6 offen offset:0
    buffer_load_dwordx4 v[36:39], v5, s[8:11], s6 offen offset:256
    buffer_load_dwordx4 v[40:43], v5, s[8:11], s6 offen offset:512
    buffer_load_dwordx4 v[44:47], v5, s[8:11], s6 offen offset:768
    buffer_load_dwordx4 v[48:51], v5, s[8:11], s21 offen offset:0
    buffer_load_dwordx4 v[52:55], v5, s[8:11], s21 offen offset:256
    buffer_load_dwordx4 v[56:59], v5, s[8:11], s21 offen offset:512
    buffer_load_dwordx4 v[60:63], v5, s[8:11], s21 offen offset:768
    s_add_u32 s40, s88, 0x70000
    s_addc_u32 s41, s89, 0
    s_mov_b32 s42, 0x40000
    s_mov_b32 s43, 0x20000
    s_lshl_b32 s20, s4, 6
    s_lshl_b32 s21, s3, 3
    s_add_u32 s20, s20, s21
    s_lshl_b32 s20, s20, 7
    v_lshlrev_b32 v6, 7, v3
    v_lshl_add_u32 v6, v4, 3, v6
    buffer_load_dwordx2 v[8:9], v6, s[40:43], s20 offen
    buffer_load_dwordx2 v[10:11], v6, s[40:43], s20 offen offset:512
    s_waitcnt vmcnt(0)
    v_mov_b32 v12, v8
    v_mov_b32 v13, v10
    s_nop 0
    v_add_f32_dpp v12, v12, v12 quad_perm:[1,0,3,2] row_mask:0xf bank_mask:0xf
    v_add_f32_dpp v13, v13, v13 quad_perm:[1,0,3,2] row_mask:0xf bank_mask:0xf
    s_nop 0
    v_add_f32_dpp v12, v12, v12 quad_perm:[2,3,0,1] row_mask:0xf bank_mask:0xf
    v_add_f32_dpp v13, v13, v13 quad_perm:[2,3,0,1] row_mask:0xf bank_mask:0xf
    s_nop 0
    v_add_f32_dpp v12, v12, v12 row_half_mirror row_mask:0xf bank_mask:0xf
    v_add_f32_dpp v13, v13, v13 row_half_mirror row_mask:0xf bank_mask:0xf
    s_nop 0
    v_add_f32_dpp v12, v12, v12 row_mirror row_mask:0xf bank_mask:0xf
    v_add_f32_dpp v13, v13, v13 row_mirror row_mask:0xf bank_mask:0xf
    v_mul_f32 v12, 0x3d800000, v12
    v_sub_f32 v14, v8, v12
    v_mul_f32 v14, v14, v14
    v_fmac_f32 v9, 0x42000000, v14
    v_mul_f32 v13, 0x3d800000, v13
    v_sub_f32 v15, v10, v13
    v_mul_f32 v15, v15, v15
    v_fmac_f32 v11, 0x42000000, v15
    v_add_f32_dpp v9, v9, v9 quad_perm:[1,0,3,2] row_mask:0xf bank_mask:0xf
    s_nop 0
    v_add_f32_dpp v11, v11, v11 quad_perm:[1,0,3,2] row_mask:0xf bank_mask:0xf
    v_add_f32_dpp v9, v9, v9 quad_perm:[2,3,0,1] row_mask:0xf bank_mask:0xf
    s_nop 0
    v_add_f32_dpp v11, v11, v11 quad_perm:[2,3,0,1] row_mask:0xf bank_mask:0xf
    v_add_f32_dpp v9, v9, v9 row_half_mirror row_mask:0xf bank_mask:0xf
    s_nop 0
    v_add_f32_dpp v11, v11, v11 row_half_mirror row_mask:0xf bank_mask:0xf
    v_add_f32_dpp v9, v9, v9 row_mirror row_mask:0xf bank_mask:0xf
    s_nop 0
    v_add_f32_dpp v11, v11, v11 row_mirror row_mask:0xf bank_mask:0xf
    v_mov_b32 v14, 0x3727c5ac
    v_fmac_f32 v14, 0x3b000000, v9
    v_rsq_f32 v20, v14
    v_mov_b32 v14, 0x3727c5ac
    v_fmac_f32 v14, 0x3b000000, v11
    v_rsq_f32 v24, v14
    v_mov_b32 v21, v20
    v_mul_f32 v22, v12, v20
    v_sub_f32 v22, 0, v22
    v_mov_b32 v23, v22
    v_mov_b32 v25, v24
    v_mul_f32 v26, v13, v24
    v_sub_f32 v26, 0, v26
    v_mov_b32 v27, v26
    v_lshlrev_b32 v128, 16, v32
    v_and_b32 v129, 0xffff0000, v32
    v_lshlrev_b32 v130, 16, v33
    v_and_b32 v131, 0xffff0000, v33
    v_lshlrev_b32 v132, 16, v34
    v_and_b32 v133, 0xffff0000, v34
    v_lshlrev_b32 v134, 16, v35
    v_and_b32 v135, 0xffff0000, v35
    v_lshlrev_b32 v136, 16, v36
    v_and_b32 v137, 0xffff0000, v36
    v_lshlrev_b32 v138, 16, v37
    v_and_b32 v139, 0xffff0000, v37
    v_lshlrev_b32 v140, 16, v38
    v_and_b32 v141, 0xffff0000, v38
    v_lshlrev_b32 v142, 16, v39
    v_and_b32 v143, 0xffff0000, v39
    v_lshlrev_b32 v144, 16, v40
    v_and_b32 v145, 0xffff0000, v40
    v_lshlrev_b32 v146, 16, v41
    v_and_b32 v147, 0xffff0000, v41
    v_lshlrev_b32 v148, 16, v42
    v_and_b32 v149, 0xffff0000, v42
    v_lshlrev_b32 v150, 16, v43
    v_and_b32 v151, 0xffff0000, v43
    v_lshlrev_b32 v152, 16, v44
    v_and_b32 v153, 0xffff0000, v44
    v_lshlrev_b32 v154, 16, v45
    v_and_b32 v155, 0xffff0000, v45
    v_lshlrev_b32 v156, 16, v46
    v_and_b32 v157, 0xffff0000, v46
    v_lshlrev_b32 v158, 16, v47
    v_and_b32 v159, 0xffff0000, v47
    v_lshlrev_b32 v160, 16, v48
    v_and_b32 v161, 0xffff0000, v48
    v_lshlrev_b32 v162, 16, v49
    v_and_b32 v163, 0xffff0000, v49
    v_lshlrev_b32 v164, 16, v50
    v_and_b32 v165, 0xffff0000, v50
    v_lshlrev_b32 v166, 16, v51
    v_and_b32 v167, 0xffff0000, v51
    v_lshlrev_b32 v168, 16, v52
    v_and_b32 v169, 0xffff0000, v52
    v_lshlrev_b32 v170, 16, v53
    v_and_b32 v171, 0xffff0000, v53
    v_lshlrev_b32 v172, 16, v54
    v_and_b32 v173, 0xffff0000, v54
    v_lshlrev_b32 v174, 16, v55
    v_and_b32 v175, 0xffff0000, v55
    v_lshlrev_b32 v176, 16, v56
    v_and_b32 v177, 0xffff0000, v56
    v_lshlrev_b32 v178, 16, v57
    v_and_b32 v179, 0xffff0000, v57
    v_lshlrev_b32 v180, 16, v58
    v_and_b32 v181, 0xffff0000, v58
    v_lshlrev_b32 v182, 16, v59
    v_and_b32 v183, 0xffff0000, v59
    v_lshlrev_b32 v184, 16, v60
    v_and_b32 v185, 0xffff0000, v60
    v_lshlrev_b32 v186, 16, v61
    v_and_b32 v187, 0xffff0000, v61
    v_lshlrev_b32 v188, 16, v62
    v_and_b32 v189, 0xffff0000, v62
    v_lshlrev_b32 v190, 16, v63
    v_and_b32 v191, 0xffff0000, v63
    v_pk_fma_f32 v[128:129], v[128:129], v[20:21], v[22:23]
    v_pk_fma_f32 v[130:131], v[130:131], v[20:21], v[22:23]
    v_pk_fma_f32 v[132:133], v[132:133], v[20:21], v[22:23]
    v_pk_fma_f32 v[134:135], v[134:135], v[20:21], v[22:23]
    v_pk_fma_f32 v[136:137], v[136:137], v[20:21], v[22:23]
    v_pk_fma_f32 v[138:139], v[138:139], v[20:21], v[22:23]
    v_pk_fma_f32 v[140:141], v[140:141], v[20:21], v[22:23]
    v_pk_fma_f32 v[142:143], v[142:143], v[20:21], v[22:23]
    v_pk_fma_f32 v[144:145], v[144:145], v[20:21], v[22:23]
    v_pk_fma_f32 v[146:147], v[146:147], v[20:21], v[22:23]
    v_pk_fma_f32 v[148:149], v[148:149], v[20:21], v[22:23]
    v_pk_fma_f32 v[150:151], v[150:151], v[20:21], v[22:23]
    v_pk_fma_f32 v[152:153], v[152:153], v[20:21], v[22:23]
    v_pk_fma_f32 v[154:155], v[154:155], v[20:21], v[22:23]
    v_pk_fma_f32 v[156:157], v[156:157], v[20:21], v[22:23]
    v_pk_fma_f32 v[158:159], v[158:159], v[20:21], v[22:23]
    v_pk_fma_f32 v[160:161], v[160:161], v[24:25], v[26:27]
    v_pk_fma_f32 v[162:163], v[162:163], v[24:25], v[26:27]
    v_pk_fma_f32 v[164:165], v[164:165], v[24:25], v[26:27]
    v_pk_fma_f32 v[166:167], v[166:167], v[24:25], v[26:27]
    v_pk_fma_f32 v[168:169], v[168:169], v[24:25], v[26:27]
    v_pk_fma_f32 v[170:171], v[170:171], v[24:25], v[26:27]
    v_pk_fma_f32 v[172:173], v[172:173], v[24:25], v[26:27]
    v_pk_fma_f32 v[174:175], v[174:175], v[24:25], v[26:27]
    v_pk_fma_f32 v[176:177], v[176:177], v[24:25], v[26:27]
    v_pk_fma_f32 v[178:179], v[178:179], v[24:25], v[26:27]
    v_pk_fma_f32 v[180:181], v[180:181], v[24:25], v[26:27]
    v_pk_fma_f32 v[182:183], v[182:183], v[24:25], v[26:27]
    v_pk_fma_f32 v[184:185], v[184:185], v[24:25], v[26:27]
    v_pk_fma_f32 v[186:187], v[186:187], v[24:25], v[26:27]
    v_pk_fma_f32 v[188:189], v[188:189], v[24:25], v[26:27]
    v_pk_fma_f32 v[190:191], v[190:191], v[24:25], v[26:27]
    s_barrier
    v_lshrrev_b32 v3, 4, v1
    v_and_b32 v4, 15, v1
    v_lshlrev_b32 v6, 4, v4
    v_add_u32 v6, 151552, v6
    ds_read_b128 v[64:67], v6 offset:2048
    ds_read_b128 v[96:99], v6 offset:0
    ds_read_b128 v[68:71], v6 offset:2304
    ds_read_b128 v[100:103], v6 offset:256
    ds_read_b128 v[72:75], v6 offset:2560
    ds_read_b128 v[104:107], v6 offset:512
    ds_read_b128 v[76:79], v6 offset:2816
    ds_read_b128 v[108:111], v6 offset:768
    ds_read_b128 v[80:83], v6 offset:3072
    ds_read_b128 v[112:115], v6 offset:1024
    ds_read_b128 v[84:87], v6 offset:3328
    ds_read_b128 v[116:119], v6 offset:1280
    ds_read_b128 v[88:91], v6 offset:3584
    ds_read_b128 v[120:123], v6 offset:1536
    ds_read_b128 v[92:95], v6 offset:3840
    ds_read_b128 v[124:127], v6 offset:1792
    s_lshl_b32 s20, s3, 3
    s_add_u32 s20, s20, 0
    v_add_u32 v15, s20, v3
    v_and_b32 v16, 15, v15
    v_xor_b32 v16, v16, v4
    v_lshlrev_b32 v15, 10, v15
    v_lshl_add_u32 v18, v16, 4, v15
    s_lshl_b32 s20, s3, 3
    s_add_u32 s20, s20, 4
    v_add_u32 v15, s20, v3
    v_and_b32 v16, 15, v15
    v_xor_b32 v16, v16, v4
    v_lshlrev_b32 v15, 10, v15
    v_lshl_add_u32 v19, v16, 4, v15
    s_waitcnt lgkmcnt(12)
    v_pk_fma_f32 v[128:129], v[128:129], v[64:65], v[96:97]
    v_pk_fma_f32 v[130:131], v[130:131], v[66:67], v[98:99]
    v_pk_fma_f32 v[132:133], v[132:133], v[68:69], v[100:101]
    v_pk_fma_f32 v[134:135], v[134:135], v[70:71], v[102:103]
    v_cvt_pk_bf16_f32 v24, v128, v129
    v_cvt_pk_bf16_f32 v25, v130, v131
    v_cvt_pk_bf16_f32 v26, v132, v133
    v_cvt_pk_bf16_f32 v27, v134, v135
    ds_write_b128 v18, v[24:27] offset:0
    v_pk_fma_f32 v[160:161], v[160:161], v[64:65], v[96:97]
    v_pk_fma_f32 v[162:163], v[162:163], v[66:67], v[98:99]
    v_pk_fma_f32 v[164:165], v[164:165], v[68:69], v[100:101]
    v_pk_fma_f32 v[166:167], v[166:167], v[70:71], v[102:103]
    v_cvt_pk_bf16_f32 v28, v160, v161
    v_cvt_pk_bf16_f32 v29, v162, v163
    v_cvt_pk_bf16_f32 v30, v164, v165
    v_cvt_pk_bf16_f32 v31, v166, v167
    ds_write_b128 v19, v[28:31] offset:0
    s_waitcnt lgkmcnt(0)
    v_pk_fma_f32 v[136:137], v[136:137], v[72:73], v[104:105]
    v_pk_fma_f32 v[138:139], v[138:139], v[74:75], v[106:107]
    v_pk_fma_f32 v[140:141], v[140:141], v[76:77], v[108:109]
    v_pk_fma_f32 v[142:143], v[142:143], v[78:79], v[110:111]
    v_cvt_pk_bf16_f32 v24, v136, v137
    v_cvt_pk_bf16_f32 v25, v138, v139
    v_cvt_pk_bf16_f32 v26, v140, v141
    v_cvt_pk_bf16_f32 v27, v142, v143
    ds_write_b128 v18, v[24:27] offset:256
    v_pk_fma_f32 v[168:169], v[168:169], v[72:73], v[104:105]
    v_pk_fma_f32 v[170:171], v[170:171], v[74:75], v[106:107]
    v_pk_fma_f32 v[172:173], v[172:173], v[76:77], v[108:109]
    v_pk_fma_f32 v[174:175], v[174:175], v[78:79], v[110:111]
    v_cvt_pk_bf16_f32 v28, v168, v169
    v_cvt_pk_bf16_f32 v29, v170, v171
    v_cvt_pk_bf16_f32 v30, v172, v173
    v_cvt_pk_bf16_f32 v31, v174, v175
    ds_write_b128 v19, v[28:31] offset:256
    s_nop 0
    v_pk_fma_f32 v[144:145], v[144:145], v[80:81], v[112:113]
    v_pk_fma_f32 v[146:147], v[146:147], v[82:83], v[114:115]
    v_pk_fma_f32 v[148:149], v[148:149], v[84:85], v[116:117]
    v_pk_fma_f32 v[150:151], v[150:151], v[86:87], v[118:119]
    v_cvt_pk_bf16_f32 v24, v144, v145
    v_cvt_pk_bf16_f32 v25, v146, v147
    v_cvt_pk_bf16_f32 v26, v148, v149
    v_cvt_pk_bf16_f32 v27, v150, v151
    ds_write_b128 v18, v[24:27] offset:512
    v_pk_fma_f32 v[176:177], v[176:177], v[80:81], v[112:113]
    v_pk_fma_f32 v[178:179], v[178:179], v[82:83], v[114:115]
    v_pk_fma_f32 v[180:181], v[180:181], v[84:85], v[116:117]
    v_pk_fma_f32 v[182:183], v[182:183], v[86:87], v[118:119]
    v_cvt_pk_bf16_f32 v28, v176, v177
    v_cvt_pk_bf16_f32 v29, v178, v179
    v_cvt_pk_bf16_f32 v30, v180, v181
    v_cvt_pk_bf16_f32 v31, v182, v183
    ds_write_b128 v19, v[28:31] offset:512
    s_nop 0
    v_pk_fma_f32 v[152:153], v[152:153], v[88:89], v[120:121]
    v_pk_fma_f32 v[154:155], v[154:155], v[90:91], v[122:123]
    v_pk_fma_f32 v[156:157], v[156:157], v[92:93], v[124:125]
    v_pk_fma_f32 v[158:159], v[158:159], v[94:95], v[126:127]
    v_cvt_pk_bf16_f32 v24, v152, v153
    v_cvt_pk_bf16_f32 v25, v154, v155
    v_cvt_pk_bf16_f32 v26, v156, v157
    v_cvt_pk_bf16_f32 v27, v158, v159
    ds_write_b128 v18, v[24:27] offset:768
    v_pk_fma_f32 v[184:185], v[184:185], v[88:89], v[120:121]
    v_pk_fma_f32 v[186:187], v[186:187], v[90:91], v[122:123]
    v_pk_fma_f32 v[188:189], v[188:189], v[92:93], v[124:125]
    v_pk_fma_f32 v[190:191], v[190:191], v[94:95], v[126:127]
    v_cvt_pk_bf16_f32 v28, v184, v185
    v_cvt_pk_bf16_f32 v29, v186, v187
    v_cvt_pk_bf16_f32 v30, v188, v189
    v_cvt_pk_bf16_f32 v31, v190, v191
    ds_write_b128 v19, v[28:31] offset:768
    v_mov_b32 v212, 0
    v_mov_b32 v213, 0
    v_mov_b32 v214, 0
    v_mov_b32 v215, 0
    v_mov_b32 v216, 0
    v_mov_b32 v217, 0
    v_mov_b32 v218, 0
    v_mov_b32 v219, 0
    v_mov_b32 v220, 0
    v_mov_b32 v221, 0
    v_mov_b32 v222, 0
    v_mov_b32 v223, 0
    v_mov_b32 v224, 0
    v_mov_b32 v225, 0
    v_mov_b32 v226, 0
    v_mov_b32 v227, 0
    v_mov_b32 v228, 0
    v_mov_b32 v229, 0
    v_mov_b32 v230, 0
    v_mov_b32 v231, 0
    v_mov_b32 v232, 0
    v_mov_b32 v233, 0
    v_mov_b32 v234, 0
    v_mov_b32 v235, 0
    v_mov_b32 v236, 0
    v_mov_b32 v237, 0
    v_mov_b32 v238, 0
    v_mov_b32 v239, 0
    v_mov_b32 v240, 0
    v_mov_b32 v241, 0
    v_mov_b32 v242, 0
    v_mov_b32 v243, 0
    s_waitcnt lgkmcnt(0)
    s_barrier
    s_cmp_ge_u32 s3, 6
    s_cbranch_scc1 win_v1_77
    ds_read_b128 v[64:67], v208 offset:0
    ds_read_b128 v[68:71], v208 offset:16384
    ds_read_b64_tr_b16 v[32:33], v200 offset:0
    ds_read_b64_tr_b16 v[34:35], v200 offset:896
    ds_read_b64_tr_b16 v[36:37], v201 offset:0
    ds_read_b64_tr_b16 v[38:39], v201 offset:896
    ds_read_b128 v[72:75], v209 offset:0
    ds_read_b128 v[76:79], v209 offset:16384
    ds_read_b64_tr_b16 v[40:41], v200 offset:7168
    ds_read_b64_tr_b16 v[42:43], v200 offset:8064
    ds_read_b64_tr_b16 v[44:45], v201 offset:7168
    ds_read_b64_tr_b16 v[46:47], v201 offset:8064
    s_barrier
    s_waitcnt lgkmcnt(6)
    v_mfma_f32_16x16x32_bf16 v[212:215], v[64:67], v[32:35], v[212:215]
    ds_read_b128 v[80:83], v210 offset:0
    ds_read_b128 v[84:87], v210 offset:16384
    v_mfma_f32_16x16x32_bf16 v[220:223], v[68:71], v[32:35], v[220:223]
    ds_read_b64_tr_b16 v[48:49], v200 offset:14336
    ds_read_b64_tr_b16 v[50:51], v200 offset:15232
    v_mfma_f32_16x16x32_bf16 v[216:219], v[64:67], v[36:39], v[216:219]
    ds_read_b64_tr_b16 v[52:53], v201 offset:14336
    ds_read_b64_tr_b16 v[54:55], v201 offset:15232
    v_mfma_f32_16x16x32_bf16 v[224:227], v[68:71], v[36:39], v[224:227]
    s_waitcnt lgkmcnt(6)
    v_mfma_f32_16x16x32_bf16 v[212:215], v[72:75], v[40:43], v[212:215]
    ds_read_b128 v[88:91], v211 offset:0
    ds_read_b128 v[92:95], v211 offset:16384
    v_mfma_f32_16x16x32_bf16 v[220:223], v[76:79], v[40:43], v[220:223]
    ds_read_b64_tr_b16 v[56:57], v200 offset:21504
    ds_read_b64_tr_b16 v[58:59], v200 offset:22400
    v_mfma_f32_16x16x32_bf16 v[216:219], v[72:75], v[44:47], v[216:219]
    ds_read_b64_tr_b16 v[60:61], v201 offset:21504
    ds_read_b64_tr_b16 v[62:63], v201 offset:22400
    v_mfma_f32_16x16x32_bf16 v[224:227], v[76:79], v[44:47], v[224:227]
    s_add_u32 s23, s34, 1146880
    s_add_u32 m0, s7, 71680
    s_nop 0
    buffer_load_dwordx4 v192, s[16:19], s23 offen lds
    s_add_u32 m0, s7, 79872
    s_nop 0
    buffer_load_dwordx4 v193, s[16:19], s23 offen lds
    s_barrier
    s_waitcnt lgkmcnt(6)
    v_mfma_f32_16x16x32_bf16 v[212:215], v[80:83], v[48:51], v[212:215]
    ds_read_b128 v[96:99], v208 offset:256
    ds_read_b128 v[100:103], v208 offset:16640
    v_mfma_f32_16x16x32_bf16 v[220:223], v[84:87], v[48:51], v[220:223]
    ds_read_b64_tr_b16 v[32:33], v200 offset:28672
    ds_read_b64_tr_b16 v[34:35], v200 offset:29568
    v_mfma_f32_16x16x32_bf16 v[216:219], v[80:83], v[52:55], v[216:219]
    ds_read_b64_tr_b16 v[36:37], v201 offset:28672
    ds_read_b64_tr_b16 v[38:39], v201 offset:29568
    v_mfma_f32_16x16x32_bf16 v[224:227], v[84:87], v[52:55], v[224:227]
    s_waitcnt lgkmcnt(6)
    v_mfma_f32_16x16x32_bf16 v[212:215], v[88:91], v[56:59], v[212:215]
    ds_read_b128 v[104:107], v209 offset:256
    ds_read_b128 v[108:111], v209 offset:16640
    v_mfma_f32_16x16x32_bf16 v[220:223], v[92:95], v[56:59], v[220:223]
    ds_read_b64_tr_b16 v[40:41], v200 offset:35840
    ds_read_b64_tr_b16 v[42:43], v200 offset:36736
    v_mfma_f32_16x16x32_bf16 v[216:219], v[88:91], v[60:63], v[216:219]
    ds_read_b64_tr_b16 v[44:45], v201 offset:35840
    ds_read_b64_tr_b16 v[46:47], v201 offset:36736
    v_mfma_f32_16x16x32_bf16 v[224:227], v[92:95], v[60:63], v[224:227]
    s_add_u32 s23, s34, 1376256
    s_add_u32 m0, s7, 0
    s_nop 0
    buffer_load_dwordx4 v192, s[16:19], s23 offen lds
    s_add_u32 m0, s7, 8192
    s_nop 0
    buffer_load_dwordx4 v193, s[16:19], s23 offen lds
    s_barrier
    s_waitcnt lgkmcnt(6)
    v_mfma_f32_16x16x32_bf16 v[212:215], v[96:99], v[32:35], v[212:215]
    ds_read_b128 v[112:115], v210 offset:256
    ds_read_b128 v[116:119], v210 offset:16640
    v_mfma_f32_16x16x32_bf16 v[220:223], v[100:103], v[32:35], v[220:223]
    ds_read_b64_tr_b16 v[48:49], v200 offset:43008
    ds_read_b64_tr_b16 v[50:51], v200 offset:43904
    v_mfma_f32_16x16x32_bf16 v[216:219], v[96:99], v[36:39], v[216:219]
    ds_read_b64_tr_b16 v[52:53], v201 offset:43008
    ds_read_b64_tr_b16 v[54:55], v201 offset:43904
    v_mfma_f32_16x16x32_bf16 v[224:227], v[100:103], v[36:39], v[224:227]
    s_waitcnt lgkmcnt(6)
    v_mfma_f32_16x16x32_bf16 v[212:215], v[104:107], v[40:43], v[212:215]
    ds_read_b128 v[120:123], v211 offset:256
    ds_read_b128 v[124:127], v211 offset:16640
    v_mfma_f32_16x16x32_bf16 v[220:223], v[108:111], v[40:43], v[220:223]
    ds_read_b64_tr_b16 v[56:57], v200 offset:50176
    ds_read_b64_tr_b16 v[58:59], v200 offset:51072
    v_mfma_f32_16x16x32_bf16 v[216:219], v[104:107], v[44:47], v[216:219]
    ds_read_b64_tr_b16 v[60:61], v201 offset:50176
    ds_read_b64_tr_b16 v[62:63], v201 offset:51072
    v_mfma_f32_16x16x32_bf16 v[224:227], v[108:111], v[44:47], v[224:227]
    s_add_u32 s23, s34, 1605632
    s_add_u32 m0, s7, 14336
    s_nop 0
    buffer_load_dwordx4 v192, s[16:19], s23 offen lds
    s_add_u32 m0, s7, 22528
    s_nop 0
    buffer_load_dwordx4 v193, s[16:19], s23 offen lds
    s_barrier
    s_waitcnt lgkmcnt(6)
    v_mfma_f32_16x16x32_bf16 v[212:215], v[112:115], v[48:51], v[212:215]
    ds_read_b128 v[128:131], v208 offset:512
    ds_read_b128 v[132:135], v208 offset:16896
    v_mfma_f32_16x16x32_bf16 v[220:223], v[116:119], v[48:51], v[220:223]
    ds_read_b64_tr_b16 v[32:33], v202 offset:0
    ds_read_b64_tr_b16 v[34:35], v202 offset:896
    v_mfma_f32_16x16x32_bf16 v[216:219], v[112:115], v[52:55], v[216:219]
    ds_read_b64_tr_b16 v[36:37], v203 offset:0
    ds_read_b64_tr_b16 v[38:39], v203 offset:896
    v_mfma_f32_16x16x32_bf16 v[224:227], v[116:119], v[52:55], v[224:227]
    s_waitcnt lgkmcnt(6)
    v_mfma_f32_16x16x32_bf16 v[212:215], v[120:123], v[56:59], v[212:215]
    ds_read_b128 v[136:139], v209 offset:512
    ds_read_b128 v[140:143], v209 offset:16896
    v_mfma_f32_16x16x32_bf16 v[220:223], v[124:127], v[56:59], v[220:223]
    ds_read_b64_tr_b16 v[40:41], v202 offset:7168
    ds_read_b64_tr_b16 v[42:43], v202 offset:8064
    v_mfma_f32_16x16x32_bf16 v[216:219], v[120:123], v[60:63], v[216:219]
    ds_read_b64_tr_b16 v[44:45], v203 offset:7168
    ds_read_b64_tr_b16 v[46:47], v203 offset:8064
    v_mfma_f32_16x16x32_bf16 v[224:227], v[124:127], v[60:63], v[224:227]
    s_add_u32 s23, s33, 0
    s_add_u32 m0, s7, 28672
    s_nop 0
    buffer_load_dwordx4 v192, s[16:19], s23 offen lds
    s_add_u32 m0, s7, 36864
    s_nop 0
    buffer_load_dwordx4 v193, s[16:19], s23 offen lds
    s_waitcnt vmcnt(6)
    s_barrier
    s_waitcnt lgkmcnt(6)
    v_mfma_f32_16x16x32_bf16 v[212:215], v[128:131], v[32:35], v[212:215]
    ds_read_b128 v[144:147], v210 offset:512
    ds_read_b128 v[148:151], v210 offset:16896
    v_mfma_f32_16x16x32_bf16 v[220:223], v[132:135], v[32:35], v[220:223]
    ds_read_b64_tr_b16 v[48:49], v202 offset:14336
    ds_read_b64_tr_b16 v[50:51], v202 offset:15232
    v_mfma_f32_16x16x32_bf16 v[216:219], v[128:131], v[36:39], v[216:219]
    ds_read_b64_tr_b16 v[52:53], v203 offset:14336
    ds_read_b64_tr_b16 v[54:55], v203 offset:15232
    v_mfma_f32_16x16x32_bf16 v[224:227], v[132:135], v[36:39], v[224:227]
    s_waitcnt lgkmcnt(6)
    v_mfma_f32_16x16x32_bf16 v[212:215], v[136:139], v[40:43], v[212:215]
    ds_read_b128 v[152:155], v211 offset:512
    ds_read_b128 v[156:159], v211 offset:16896
    v_mfma_f32_16x16x32_bf16 v[220:223], v[140:143], v[40:43], v[220:223]
    ds_read_b64_tr_b16 v[56:57], v202 offset:21504
    ds_read_b64_tr_b16 v[58:59], v202 offset:22400
    v_mfma_f32_16x16x32_bf16 v[216:219], v[136:139], v[44:47], v[216:219]
    ds_read_b64_tr_b16 v[60:61], v203 offset:21504
    ds_read_b64_tr_b16 v[62:63], v203 offset:22400
    v_mfma_f32_16x16x32_bf16 v[224:227], v[140:143], v[44:47], v[224:227]
    s_add_u32 s23, s33, 229376
    s_add_u32 m0, s7, 43008
    s_nop 0
    buffer_load_dwordx4 v192, s[16:19], s23 offen lds
    s_add_u32 m0, s7, 51200
    s_nop 0
    buffer_load_dwordx4 v193, s[16:19], s23 offen lds
    s_waitcnt vmcnt(6)
    s_barrier
    s_waitcnt lgkmcnt(6)
    v_mfma_f32_16x16x32_bf16 v[212:215], v[144:147], v[48:51], v[212:215]
    ds_read_b128 v[160:163], v208 offset:768
    ds_read_b128 v[164:167], v208 offset:17152
    v_mfma_f32_16x16x32_bf16 v[220:223], v[148:151], v[48:51], v[220:223]
    ds_read_b64_tr_b16 v[32:33], v200 offset:0
    ds_read_b64_tr_b16 v[34:35], v200 offset:896
    v_mfma_f32_16x16x32_bf16 v[216:219], v[144:147], v[52:55], v[216:219]
    ds_read_b64_tr_b16 v[36:37], v201 offset:0
    ds_read_b64_tr_b16 v[38:39], v201 offset:896
    v_mfma_f32_16x16x32_bf16 v[224:227], v[148:151], v[52:55], v[224:227]
    s_waitcnt lgkmcnt(6)
    v_mfma_f32_16x16x32_bf16 v[212:215], v[152:155], v[56:59], v[212:215]
    ds_read_b128 v[168:171], v209 offset:768
    ds_read_b128 v[172:175], v209 offset:17152
    v_mfma_f32_16x16x32_bf16 v[220:223], v[156:159], v[56:59], v[220:223]
    ds_read_b64_tr_b16 v[40:41], v200 offset:7168
    ds_read_b64_tr_b16 v[42:43], v200 offset:8064
    v_mfma_f32_16x16x32_bf16 v[216:219], v[152:155], v[60:63], v[216:219]
    ds_read_b64_tr_b16 v[44:45], v201 offset:7168
    ds_read_b64_tr_b16 v[46:47], v201 offset:8064
    v_mfma_f32_16x16x32_bf16 v[224:227], v[156:159], v[60:63], v[224:227]
    s_add_u32 s23, s33, 458752
    s_add_u32 m0, s7, 57344
    s_nop 0
    buffer_load_dwordx4 v192, s[16:19], s23 offen lds
    s_add_u32 m0, s7, 65536
    s_nop 0
    buffer_load_dwordx4 v193, s[16:19], s23 offen lds
    s_waitcnt vmcnt(6)
    s_barrier
    s_waitcnt lgkmcnt(6)
    v_mfma_f32_16x16x32_bf16 v[212:215], v[160:163], v[32:35], v[212:215]
    ds_read_b128 v[176:179], v210 offset:768
    ds_read_b128 v[180:183], v210 offset:17152
    v_mfma_f32_16x16x32_bf16 v[220:223], v[164:167], v[32:35], v[220:223]
    ds_read_b64_tr_b16 v[48:49], v200 offset:14336
    ds_read_b64_tr_b16 v[50:51], v200 offset:15232
    v_mfma_f32_16x16x32_bf16 v[216:219], v[160:163], v[36:39], v[216:219]
    ds_read_b64_tr_b16 v[52:53], v201 offset:14336
    ds_read_b64_tr_b16 v[54:55], v201 offset:15232
    v_mfma_f32_16x16x32_bf16 v[224:227], v[164:167], v[36:39], v[224:227]
    s_waitcnt lgkmcnt(6)
    v_mfma_f32_16x16x32_bf16 v[212:215], v[168:171], v[40:43], v[212:215]
    ds_read_b128 v[184:187], v211 offset:768
    ds_read_b128 v[188:191], v211 offset:17152
    v_mfma_f32_16x16x32_bf16 v[220:223], v[172:175], v[40:43], v[220:223]
    ds_read_b64_tr_b16 v[56:57], v200 offset:21504
    ds_read_b64_tr_b16 v[58:59], v200 offset:22400
    v_mfma_f32_16x16x32_bf16 v[216:219], v[168:171], v[44:47], v[216:219]
    ds_read_b64_tr_b16 v[60:61], v201 offset:21504
    ds_read_b64_tr_b16 v[62:63], v201 offset:22400
    v_mfma_f32_16x16x32_bf16 v[224:227], v[172:175], v[44:47], v[224:227]
    s_add_u32 s23, s33, 688128
    s_add_u32 m0, s7, 71680
    s_nop 0
    buffer_load_dwordx4 v192, s[16:19], s23 offen lds
    s_add_u32 m0, s7, 79872
    s_nop 0
    buffer_load_dwordx4 v193, s[16:19], s23 offen lds
    s_waitcnt vmcnt(6)
    s_barrier
    s_waitcnt lgkmcnt(6)
    v_mfma_f32_16x16x32_bf16 v[212:215], v[176:179], v[48:51], v[212:215]
    ds_read_b64_tr_b16 v[32:33], v200 offset:28672
    ds_read_b64_tr_b16 v[34:35], v200 offset:29568
    v_mfma_f32_16x16x32_bf16 v[220:223], v[180:183], v[48:51], v[220:223]
    ds_read_b64_tr_b16 v[36:37], v201 offset:28672
    ds_read_b64_tr_b16 v[38:39], v201 offset:29568
    v_mfma_f32_16x16x32_bf16 v[216:219], v[176:179], v[52:55], v[216:219]
    v_mfma_f32_16x16x32_bf16 v[224:227], v[180:183], v[52:55], v[224:227]
    s_waitcnt lgkmcnt(4)
    v_mfma_f32_16x16x32_bf16 v[212:215], v[184:187], v[56:59], v[212:215]
    ds_read_b64_tr_b16 v[40:41], v200 offset:35840
    ds_read_b64_tr_b16 v[42:43], v200 offset:36736
    v_mfma_f32_16x16x32_bf16 v[220:223], v[188:191], v[56:59], v[220:223]
    ds_read_b64_tr_b16 v[44:45], v201 offset:35840
    ds_read_b64_tr_b16 v[46:47], v201 offset:36736
    v_mfma_f32_16x16x32_bf16 v[216:219], v[184:187], v[60:63], v[216:219]
    v_mfma_f32_16x16x32_bf16 v[224:227], v[188:191], v[60:63], v[224:227]
    s_add_u32 s23, s33, 917504
    s_add_u32 m0, s7, 0
    s_nop 0
    buffer_load_dwordx4 v192, s[16:19], s23 offen lds
    s_add_u32 m0, s7, 8192
    s_nop 0
    buffer_load_dwordx4 v193, s[16:19], s23 offen lds
    s_mov_b32 s20, 0xbdd2d3e8
    v_mov_b32 v20, 0xc0135761
    v_mul_f32 v24, v212, v212
    v_mul_f32 v25, v213, v213
    v_mul_f32 v26, v214, v214
    v_mul_f32 v27, v215, v215
    v_fma_f32 v24, v24, s20, v20
    v_fma_f32 v25, v25, s20, v20
    v_fma_f32 v26, v26, s20, v20
    v_fma_f32 v27, v27, s20, v20
    v_mul_f32 v24, v24, v212
    v_mul_f32 v25, v25, v213
    v_mul_f32 v26, v26, v214
    v_mul_f32 v27, v27, v215
    v_exp_f32 v24, v24
    v_exp_f32 v25, v25
    v_exp_f32 v26, v26
    v_exp_f32 v27, v27
    v_add_f32 v24, 1.0, v24
    v_add_f32 v25, 1.0, v25
    v_add_f32 v26, 1.0, v26
    v_add_f32 v27, 1.0, v27
    v_rcp_f32 v24, v24
    v_rcp_f32 v25, v25
    v_rcp_f32 v26, v26
    v_rcp_f32 v27, v27
    v_mul_f32 v212, v212, v24
    v_mul_f32 v213, v213, v25
    v_mul_f32 v214, v214, v26
    v_mul_f32 v215, v215, v27
    v_mul_f32 v24, v220, v220
    v_mul_f32 v25, v221, v221
    v_mul_f32 v26, v222, v222
    v_mul_f32 v27, v223, v223
    v_fma_f32 v24, v24, s20, v20
    v_fma_f32 v25, v25, s20, v20
    v_fma_f32 v26, v26, s20, v20
    v_fma_f32 v27, v27, s20, v20
    v_mul_f32 v24, v24, v220
    v_mul_f32 v25, v25, v221
    v_mul_f32 v26, v26, v222
    v_mul_f32 v27, v27, v223
    v_exp_f32 v24, v24
    v_exp_f32 v25, v25
    v_exp_f32 v26, v26
    v_exp_f32 v27, v27
    v_add_f32 v24, 1.0, v24
    v_add_f32 v25, 1.0, v25
    v_add_f32 v26, 1.0, v26
    v_add_f32 v27, 1.0, v27
    v_rcp_f32 v24, v24
    v_rcp_f32 v25, v25
    v_rcp_f32 v26, v26
    v_rcp_f32 v27, v27
    v_mul_f32 v220, v220, v24
    v_mul_f32 v221, v221, v25
    v_mul_f32 v222, v222, v26
    v_mul_f32 v223, v223, v27
    v_mul_f32 v24, v216, v216
    v_mul_f32 v25, v217, v217
    v_mul_f32 v26, v218, v218
    v_mul_f32 v27, v219, v219
    v_fma_f32 v24, v24, s20, v20
    v_fma_f32 v25, v25, s20, v20
    v_fma_f32 v26, v26, s20, v20
    v_fma_f32 v27, v27, s20, v20
    v_mul_f32 v24, v24, v216
    v_mul_f32 v25, v25, v217
    v_mul_f32 v26, v26, v218
    v_mul_f32 v27, v27, v219
    v_exp_f32 v24, v24
    v_exp_f32 v25, v25
    v_exp_f32 v26, v26
    v_exp_f32 v27, v27
    v_add_f32 v24, 1.0, v24
    v_add_f32 v25, 1.0, v25
    v_add_f32 v26, 1.0, v26
    v_add_f32 v27, 1.0, v27
    v_rcp_f32 v24, v24
    v_rcp_f32 v25, v25
    v_rcp_f32 v26, v26
    v_rcp_f32 v27, v27
    v_mul_f32 v216, v216, v24
    v_mul_f32 v217, v217, v25
    v_mul_f32 v218, v218, v26
    v_mul_f32 v219, v219, v27
    v_mul_f32 v24, v224, v224
    v_mul_f32 v25, v225, v225
    v_mul_f32 v26, v226, v226
    v_mul_f32 v27, v227, v227
    v_fma_f32 v24, v24, s20, v20
    v_fma_f32 v25, v25, s20, v20
    v_fma_f32 v26, v26, s20, v20
    v_fma_f32 v27, v27, s20, v20
    v_mul_f32 v24, v24, v224
    v_mul_f32 v25, v25, v225
    v_mul_f32 v26, v26, v226
    v_mul_f32 v27, v27, v227
    v_exp_f32 v24, v24
    v_exp_f32 v25, v25
    v_exp_f32 v26, v26
    v_exp_f32 v27, v27
    v_add_f32 v24, 1.0, v24
    v_add_f32 v25, 1.0, v25
    v_add_f32 v26, 1.0, v26
    v_add_f32 v27, 1.0, v27
    v_rcp_f32 v24, v24
    v_rcp_f32 v25, v25
    v_rcp_f32 v26, v26
    v_rcp_f32 v27, v27
    v_mul_f32 v224, v224, v24
    v_mul_f32 v225, v225, v25
    v_mul_f32 v226, v226, v26
    v_mul_f32 v227, v227, v27
    v_lshrrev_b32 v3, 4, v1
    v_and_b32 v4, 15, v1
    v_mov_b32 v8, v212
    v_mul_f32 v9, v212, v212
    v_add_f32 v8, v8, v216
    v_fmac_f32 v9, v216, v216
    v_mov_b32 v10, v213
    v_mul_f32 v11, v213, v213
    v_add_f32 v10, v10, v217
    v_fmac_f32 v11, v217, v217
    v_mov_b32 v12, v214
    v_mul_f32 v13, v214, v214
    v_add_f32 v12, v12, v218
    v_fmac_f32 v13, v218, v218
    v_mov_b32 v14, v215
    v_mul_f32 v15, v215, v215
    v_add_f32 v14, v14, v219
    v_fmac_f32 v15, v219, v219
    v_mov_b32 v16, v220
    v_mul_f32 v17, v220, v220
    v_add_f32 v16, v16, v224
    v_fmac_f32 v17, v224, v224
    v_mov_b32 v18, v221
    v_mul_f32 v19, v221, v221
    v_add_f32 v18, v18, v225
    v_fmac_f32 v19, v225, v225
    v_mov_b32 v28, v222
    v_mul_f32 v29, v222, v222
    v_add_f32 v28, v28, v226
    v_fmac_f32 v29, v226, v226
    v_mov_b32 v30, v223
    v_mul_f32 v31, v223, v223
    v_add_f32 v30, v30, v227
    v_fmac_f32 v31, v227, v227
    v_add_f32_dpp v8, v8, v8 quad_perm:[1,0,3,2] row_mask:0xf bank_mask:0xf
    v_add_f32_dpp v9, v9, v9 quad_perm:[1,0,3,2] row_mask:0xf bank_mask:0xf
    v_add_f32_dpp v10, v10, v10 quad_perm:[1,0,3,2] row_mask:0xf bank_mask:0xf
    v_add_f32_dpp v11, v11, v11 quad_perm:[1,0,3,2] row_mask:0xf bank_mask:0xf
    v_add_f32_dpp v12, v12, v12 quad_perm:[1,0,3,2] row_mask:0xf bank_mask:0xf
    v_add_f32_dpp v13, v13, v13 quad_perm:[1,0,3,2] row_mask:0xf bank_mask:0xf
    v_add_f32_dpp v14, v14, v14 quad_perm:[1,0,3,2] row_mask:0xf bank_mask:0xf
    v_add_f32_dpp v15, v15, v15 quad_perm:[1,0,3,2] row_mask:0xf bank_mask:0xf
    v_add_f32_dpp v16, v16, v16 quad_perm:[1,0,3,2] row_mask:0xf bank_mask:0xf
    v_add_f32_dpp v17, v17, v17 quad_perm:[1,0,3,2] row_mask:0xf bank_mask:0xf
    v_add_f32_dpp v18, v18, v18 quad_perm:[1,0,3,2] row_mask:0xf bank_mask:0xf
    v_add_f32_dpp v19, v19, v19 quad_perm:[1,0,3,2] row_mask:0xf bank_mask:0xf
    v_add_f32_dpp v28, v28, v28 quad_perm:[1,0,3,2] row_mask:0xf bank_mask:0xf
    v_add_f32_dpp v29, v29, v29 quad_perm:[1,0,3,2] row_mask:0xf bank_mask:0xf
    v_add_f32_dpp v30, v30, v30 quad_perm:[1,0,3,2] row_mask:0xf bank_mask:0xf
    v_add_f32_dpp v31, v31, v31 quad_perm:[1,0,3,2] row_mask:0xf bank_mask:0xf
    v_add_f32_dpp v8, v8, v8 quad_perm:[2,3,0,1] row_mask:0xf bank_mask:0xf
    v_add_f32_dpp v9, v9, v9 quad_perm:[2,3,0,1] row_mask:0xf bank_mask:0xf
    v_add_f32_dpp v10, v10, v10 quad_perm:[2,3,0,1] row_mask:0xf bank_mask:0xf
    v_add_f32_dpp v11, v11, v11 quad_perm:[2,3,0,1] row_mask:0xf bank_mask:0xf
    v_add_f32_dpp v12, v12, v12 quad_perm:[2,3,0,1] row_mask:0xf bank_mask:0xf
    v_add_f32_dpp v13, v13, v13 quad_perm:[2,3,0,1] row_mask:0xf bank_mask:0xf
    v_add_f32_dpp v14, v14, v14 quad_perm:[2,3,0,1] row_mask:0xf bank_mask:0xf
    v_add_f32_dpp v15, v15, v15 quad_perm:[2,3,0,1] row_mask:0xf bank_mask:0xf
    v_add_f32_dpp v16, v16, v16 quad_perm:[2,3,0,1] row_mask:0xf bank_mask:0xf
    v_add_f32_dpp v17, v17, v17 quad_perm:[2,3,0,1] row_mask:0xf bank_mask:0xf
    v_add_f32_dpp v18, v18, v18 quad_perm:[2,3,0,1] row_mask:0xf bank_mask:0xf
    v_add_f32_dpp v19, v19, v19 quad_perm:[2,3,0,1] row_mask:0xf bank_mask:0xf
    v_add_f32_dpp v28, v28, v28 quad_perm:[2,3,0,1] row_mask:0xf bank_mask:0xf
    v_add_f32_dpp v29, v29, v29 quad_perm:[2,3,0,1] row_mask:0xf bank_mask:0xf
    v_add_f32_dpp v30, v30, v30 quad_perm:[2,3,0,1] row_mask:0xf bank_mask:0xf
    v_add_f32_dpp v31, v31, v31 quad_perm:[2,3,0,1] row_mask:0xf bank_mask:0xf
    v_add_f32_dpp v8, v8, v8 row_half_mirror row_mask:0xf bank_mask:0xf
    v_add_f32_dpp v9, v9, v9 row_half_mirror row_mask:0xf bank_mask:0xf
    v_add_f32_dpp v10, v10, v10 row_half_mirror row_mask:0xf bank_mask:0xf
    v_add_f32_dpp v11, v11, v11 row_half_mirror row_mask:0xf bank_mask:0xf
    v_add_f32_dpp v12, v12, v12 row_half_mirror row_mask:0xf bank_mask:0xf
    v_add_f32_dpp v13, v13, v13 row_half_mirror row_mask:0xf bank_mask:0xf
    v_add_f32_dpp v14, v14, v14 row_half_mirror row_mask:0xf bank_mask:0xf
    v_add_f32_dpp v15, v15, v15 row_half_mirror row_mask:0xf bank_mask:0xf
    v_add_f32_dpp v16, v16, v16 row_half_mirror row_mask:0xf bank_mask:0xf
    v_add_f32_dpp v17, v17, v17 row_half_mirror row_mask:0xf bank_mask:0xf
    v_add_f32_dpp v18, v18, v18 row_half_mirror row_mask:0xf bank_mask:0xf
    v_add_f32_dpp v19, v19, v19 row_half_mirror row_mask:0xf bank_mask:0xf
    v_add_f32_dpp v28, v28, v28 row_half_mirror row_mask:0xf bank_mask:0xf
    v_add_f32_dpp v29, v29, v29 row_half_mirror row_mask:0xf bank_mask:0xf
    v_add_f32_dpp v30, v30, v30 row_half_mirror row_mask:0xf bank_mask:0xf
    v_add_f32_dpp v31, v31, v31 row_half_mirror row_mask:0xf bank_mask:0xf
    v_add_f32_dpp v8, v8, v8 row_mirror row_mask:0xf bank_mask:0xf
    v_add_f32_dpp v9, v9, v9 row_mirror row_mask:0xf bank_mask:0xf
    v_add_f32_dpp v10, v10, v10 row_mirror row_mask:0xf bank_mask:0xf
    v_add_f32_dpp v11, v11, v11 row_mirror row_mask:0xf bank_mask:0xf
    v_add_f32_dpp v12, v12, v12 row_mirror row_mask:0xf bank_mask:0xf
    v_add_f32_dpp v13, v13, v13 row_mirror row_mask:0xf bank_mask:0xf
    v_add_f32_dpp v14, v14, v14 row_mirror row_mask:0xf bank_mask:0xf
    v_add_f32_dpp v15, v15, v15 row_mirror row_mask:0xf bank_mask:0xf
    v_add_f32_dpp v16, v16, v16 row_mirror row_mask:0xf bank_mask:0xf
    v_add_f32_dpp v17, v17, v17 row_mirror row_mask:0xf bank_mask:0xf
    v_add_f32_dpp v18, v18, v18 row_mirror row_mask:0xf bank_mask:0xf
    v_add_f32_dpp v19, v19, v19 row_mirror row_mask:0xf bank_mask:0xf
    v_add_f32_dpp v28, v28, v28 row_mirror row_mask:0xf bank_mask:0xf
    v_add_f32_dpp v29, v29, v29 row_mirror row_mask:0xf bank_mask:0xf
    v_add_f32_dpp v30, v30, v30 row_mirror row_mask:0xf bank_mask:0xf
    v_add_f32_dpp v31, v31, v31 row_mirror row_mask:0xf bank_mask:0xf
    s_and_b32 s20, s3, 1
    s_lshl_b32 s20, s20, 8
    s_lshr_b32 s21, s3, 1
    s_lshl_b32 s21, s21, 9
    s_add_u32 s20, s20, s21
    s_add_u32 s20, s20, 155648
    v_lshlrev_b32 v5, 5, v3
    v_add_u32 v5, s20, v5
    v_cmp_eq_u32 vcc, 0, v4
    s_nop 3
    s_and_saveexec_b64 s[44:45], vcc
    ds_write_b64 v5, v[8:9] offset:0
    ds_write_b64 v5, v[10:11] offset:8
    ds_write_b64 v5, v[12:13] offset:16
    ds_write_b64 v5, v[14:15] offset:24
    ds_write_b64 v5, v[16:17] offset:128
    ds_write_b64 v5, v[18:19] offset:136
    ds_write_b64 v5, v[28:29] offset:144
    ds_write_b64 v5, v[30:31] offset:152
    s_mov_b64 exec, s[44:45]
    s_waitcnt lgkmcnt(0)
    s_waitcnt vmcnt(6)
    s_barrier
    s_cmp_lg_u32 s3, 0
    s_cbranch_scc1 win_pub_79
    v_lshlrev_b32 v5, 3, v1
    v_add_u32 v5, 155648, v5
    ds_read_b64 v[8:9], v5 offset:0
    ds_read_b64 v[10:11], v5 offset:512
    ds_read_b64 v[12:13], v5 offset:1024
    ds_read_b64 v[14:15], v5 offset:1536
    s_waitcnt lgkmcnt(0)
    v_pk_add_f32 v[8:9], v[8:9], v[10:11]
    v_pk_add_f32 v[12:13], v[12:13], v[14:15]
    v_pk_add_f32 v[8:9], v[8:9], v[12:13]
    v_mov_b32 v10, s59
    v_mov_b32 v11, s59
    v_lshlrev_b32 v6, 4, v1
    s_lshl_b32 s20, s4, 13
    s_lshl_b32 s21, s5, 10
    s_add_u32 s21, s21, s20
    buffer_store_dwordx4 v[8:11], v6, s[36:39], s21 offen sc1
win_pub_79:
    s_waitcnt lgkmcnt(0)
    v_mfma_f32_16x16x32_bf16 v[228:231], v[32:35], v[64:67], v[228:231]
    ds_read_b64_tr_b16 v[48:49], v200 offset:43008
    ds_read_b64_tr_b16 v[50:51], v200 offset:43904
    v_mfma_f32_16x16x32_bf16 v[236:239], v[32:35], v[68:71], v[236:239]
    ds_read_b64_tr_b16 v[52:53], v201 offset:43008
    ds_read_b64_tr_b16 v[54:55], v201 offset:43904
    v_mfma_f32_16x16x32_bf16 v[232:235], v[36:39], v[64:67], v[232:235]
    v_mfma_f32_16x16x32_bf16 v[240:243], v[36:39], v[68:71], v[240:243]
    s_waitcnt lgkmcnt(4)
    v_mfma_f32_16x16x32_bf16 v[228:231], v[40:43], v[72:75], v[228:231]
    ds_read_b64_tr_b16 v[56:57], v200 offset:50176
    ds_read_b64_tr_b16 v[58:59], v200 offset:51072
    v_mfma_f32_16x16x32_bf16 v[236:239], v[40:43], v[76:79], v[236:239]
    ds_read_b64_tr_b16 v[60:61], v201 offset:50176
    ds_read_b64_tr_b16 v[62:63], v201 offset:51072
    v_mfma_f32_16x16x32_bf16 v[232:235], v[44:47], v[72:75], v[232:235]
    v_mfma_f32_16x16x32_bf16 v[240:243], v[44:47], v[76:79], v[240:243]
    s_add_u32 s23, s33, 1146880
    s_add_u32 m0, s7, 14336
    s_nop 0
    buffer_load_dwordx4 v192, s[16:19], s23 offen lds
    s_add_u32 m0, s7, 22528
    s_nop 0
    buffer_load_dwordx4 v193, s[16:19], s23 offen lds
    s_waitcnt vmcnt(6)
    s_barrier
    s_waitcnt lgkmcnt(4)
    v_mfma_f32_16x16x32_bf16 v[228:231], v[48:51], v[80:83], v[228:231]
    ds_read_b64_tr_b16 v[32:33], v202 offset:0
    ds_read_b64_tr_b16 v[34:35], v202 offset:896
    v_mfma_f32_16x16x32_bf16 v[236:239], v[48:51], v[84:87], v[236:239]
    ds_read_b64_tr_b16 v[36:37], v203 offset:0
    ds_read_b64_tr_b16 v[38:39], v203 offset:896
    v_mfma_f32_16x16x32_bf16 v[232:235], v[52:55], v[80:83], v[232:235]
    v_mfma_f32_16x16x32_bf16 v[240:243], v[52:55], v[84:87], v[240:243]
    s_waitcnt lgkmcnt(4)
    v_mfma_f32_16x16x32_bf16 v[228:231], v[56:59], v[88:91], v[228:231]
    ds_read_b64_tr_b16 v[40:41], v202 offset:7168
    ds_read_b64_tr_b16 v[42:43], v202 offset:8064
    v_mfma_f32_16x16x32_bf16 v[236:239], v[56:59], v[92:95], v[236:239]
    ds_read_b64_tr_b16 v[44:45], v203 offset:7168
    ds_read_b64_tr_b16 v[46:47], v203 offset:8064
    v_mfma_f32_16x16x32_bf16 v[232:235], v[60:63], v[88:91], v[232:235]
    v_mfma_f32_16x16x32_bf16 v[240:243], v[60:63], v[92:95], v[240:243]
    s_add_u32 s23, s33, 1376256
    s_add_u32 m0, s7, 28672
    s_nop 0
    buffer_load_dwordx4 v192, s[16:19], s23 offen lds
    s_add_u32 m0, s7, 36864
    s_nop 0
    buffer_load_dwordx4 v193, s[16:19], s23 offen lds
    s_waitcnt vmcnt(6)
    s_barrier
    s_waitcnt lgkmcnt(4)
    v_mfma_f32_16x16x32_bf16 v[228:231], v[32:35], v[96:99], v[228:231]
    ds_read_b64_tr_b16 v[48:49], v202 offset:14336
    ds_read_b64_tr_b16 v[50:51], v202 offset:15232
    v_mfma_f32_16x16x32_bf16 v[236:239], v[32:35], v[100:103], v[236:239]
    ds_read_b64_tr_b16 v[52:53], v203 offset:14336
    ds_read_b64_tr_b16 v[54:55], v203 offset:15232
    v_mfma_f32_16x16x32_bf16 v[232:235], v[36:39], v[96:99], v[232:235]
    v_mfma_f32_16x16x32_bf16 v[240:243], v[36:39], v[100:103], v[240:243]
    s_waitcnt lgkmcnt(4)
    v_mfma_f32_16x16x32_bf16 v[228:231], v[40:43], v[104:107], v[228:231]
    ds_read_b64_tr_b16 v[56:57], v202 offset:21504
    ds_read_b64_tr_b16 v[58:59], v202 offset:22400
    v_mfma_f32_16x16x32_bf16 v[236:239], v[40:43], v[108:111], v[236:239]
    ds_read_b64_tr_b16 v[60:61], v203 offset:21504
    ds_read_b64_tr_b16 v[62:63], v203 offset:22400
    v_mfma_f32_16x16x32_bf16 v[232:235], v[44:47], v[104:107], v[232:235]
    v_mfma_f32_16x16x32_bf16 v[240:243], v[44:47], v[108:111], v[240:243]
    s_add_u32 s23, s33, 1605632
    s_add_u32 m0, s7, 43008
    s_nop 0
    buffer_load_dwordx4 v192, s[16:19], s23 offen lds
    s_add_u32 m0, s7, 51200
    s_nop 0
    buffer_load_dwordx4 v193, s[16:19], s23 offen lds
    s_waitcnt vmcnt(6)
    s_barrier
    s_waitcnt lgkmcnt(4)
    v_mfma_f32_16x16x32_bf16 v[228:231], v[48:51], v[112:115], v[228:231]
    ds_read_b64_tr_b16 v[32:33], v200 offset:0
    ds_read_b64_tr_b16 v[34:35], v200 offset:896
    v_mfma_f32_16x16x32_bf16 v[236:239], v[48:51], v[116:119], v[236:239]
    ds_read_b64_tr_b16 v[36:37], v201 offset:0
    ds_read_b64_tr_b16 v[38:39], v201 offset:896
    v_mfma_f32_16x16x32_bf16 v[232:235], v[52:55], v[112:115], v[232:235]
    v_mfma_f32_16x16x32_bf16 v[240:243], v[52:55], v[116:119], v[240:243]
    s_waitcnt lgkmcnt(4)
    v_mfma_f32_16x16x32_bf16 v[228:231], v[56:59], v[120:123], v[228:231]
    ds_read_b64_tr_b16 v[40:41], v200 offset:7168
    ds_read_b64_tr_b16 v[42:43], v200 offset:8064
    v_mfma_f32_16x16x32_bf16 v[236:239], v[56:59], v[124:127], v[236:239]
    ds_read_b64_tr_b16 v[44:45], v201 offset:7168
    ds_read_b64_tr_b16 v[46:47], v201 offset:8064
    v_mfma_f32_16x16x32_bf16 v[232:235], v[60:63], v[120:123], v[232:235]
    v_mfma_f32_16x16x32_bf16 v[240:243], v[60:63], v[124:127], v[240:243]
    s_waitcnt vmcnt(4)
    s_barrier
    s_waitcnt lgkmcnt(4)
    v_mfma_f32_16x16x32_bf16 v[228:231], v[32:35], v[128:131], v[228:231]
    ds_read_b64_tr_b16 v[48:49], v200 offset:14336
    ds_read_b64_tr_b16 v[50:51], v200 offset:15232
    v_mfma_f32_16x16x32_bf16 v[236:239], v[32:35], v[132:135], v[236:239]
    ds_read_b64_tr_b16 v[52:53], v201 offset:14336
    ds_read_b64_tr_b16 v[54:55], v201 offset:15232
    v_mfma_f32_16x16x32_bf16 v[232:235], v[36:39], v[128:131], v[232:235]
    v_mfma_f32_16x16x32_bf16 v[240:243], v[36:39], v[132:135], v[240:243]
    s_waitcnt lgkmcnt(4)
    v_mfma_f32_16x16x32_bf16 v[228:231], v[40:43], v[136:139], v[228:231]
    ds_read_b64_tr_b16 v[56:57], v200 offset:21504
    ds_read_b64_tr_b16 v[58:59], v200 offset:22400
    v_mfma_f32_16x16x32_bf16 v[236:239], v[40:43], v[140:143], v[236:239]
    ds_read_b64_tr_b16 v[60:61], v201 offset:21504
    ds_read_b64_tr_b16 v[62:63], v201 offset:22400
    v_mfma_f32_16x16x32_bf16 v[232:235], v[44:47], v[136:139], v[232:235]
    v_mfma_f32_16x16x32_bf16 v[240:243], v[44:47], v[140:143], v[240:243]
    s_waitcnt vmcnt(2)
    s_barrier
    s_waitcnt lgkmcnt(4)
    v_mfma_f32_16x16x32_bf16 v[228:231], v[48:51], v[144:147], v[228:231]
    ds_read_b64_tr_b16 v[32:33], v200 offset:28672
    ds_read_b64_tr_b16 v[34:35], v200 offset:29568
    v_mfma_f32_16x16x32_bf16 v[236:239], v[48:51], v[148:151], v[236:239]
    ds_read_b64_tr_b16 v[36:37], v201 offset:28672
    ds_read_b64_tr_b16 v[38:39], v201 offset:29568
    v_mfma_f32_16x16x32_bf16 v[232:235], v[52:55], v[144:147], v[232:235]
    v_mfma_f32_16x16x32_bf16 v[240:243], v[52:55], v[148:151], v[240:243]
    s_waitcnt lgkmcnt(4)
    v_mfma_f32_16x16x32_bf16 v[228:231], v[56:59], v[152:155], v[228:231]
    ds_read_b64_tr_b16 v[40:41], v200 offset:35840
    ds_read_b64_tr_b16 v[42:43], v200 offset:36736
    v_mfma_f32_16x16x32_bf16 v[236:239], v[56:59], v[156:159], v[236:239]
    ds_read_b64_tr_b16 v[44:45], v201 offset:35840
    ds_read_b64_tr_b16 v[46:47], v201 offset:36736
    v_mfma_f32_16x16x32_bf16 v[232:235], v[60:63], v[152:155], v[232:235]
    v_mfma_f32_16x16x32_bf16 v[240:243], v[60:63], v[156:159], v[240:243]
    s_waitcnt vmcnt(0)
    s_barrier
    s_waitcnt lgkmcnt(4)
    v_mfma_f32_16x16x32_bf16 v[228:231], v[32:35], v[160:163], v[228:231]
    ds_read_b64_tr_b16 v[48:49], v200 offset:43008
    ds_read_b64_tr_b16 v[50:51], v200 offset:43904
    v_mfma_f32_16x16x32_bf16 v[236:239], v[32:35], v[164:167], v[236:239]
    ds_read_b64_tr_b16 v[52:53], v201 offset:43008
    ds_read_b64_tr_b16 v[54:55], v201 offset:43904
    v_mfma_f32_16x16x32_bf16 v[232:235], v[36:39], v[160:163], v[232:235]
    v_mfma_f32_16x16x32_bf16 v[240:243], v[36:39], v[164:167], v[240:243]
    s_waitcnt lgkmcnt(4)
    v_mfma_f32_16x16x32_bf16 v[228:231], v[40:43], v[168:171], v[228:231]
    ds_read_b64_tr_b16 v[56:57], v200 offset:50176
    ds_read_b64_tr_b16 v[58:59], v200 offset:51072
    v_mfma_f32_16x16x32_bf16 v[236:239], v[40:43], v[172:175], v[236:239]
    ds_read_b64_tr_b16 v[60:61], v201 offset:50176
    ds_read_b64_tr_b16 v[62:63], v201 offset:51072
    v_mfma_f32_16x16x32_bf16 v[232:235], v[44:47], v[168:171], v[232:235]
    v_mfma_f32_16x16x32_bf16 v[240:243], v[44:47], v[172:175], v[240:243]
    s_waitcnt lgkmcnt(4)
    v_mfma_f32_16x16x32_bf16 v[228:231], v[48:51], v[176:179], v[228:231]
    v_mfma_f32_16x16x32_bf16 v[236:239], v[48:51], v[180:183], v[236:239]
    v_mfma_f32_16x16x32_bf16 v[232:235], v[52:55], v[176:179], v[232:235]
    v_mfma_f32_16x16x32_bf16 v[240:243], v[52:55], v[180:183], v[240:243]
    s_waitcnt lgkmcnt(0)
    v_mfma_f32_16x16x32_bf16 v[228:231], v[56:59], v[184:187], v[228:231]
    v_mfma_f32_16x16x32_bf16 v[236:239], v[56:59], v[188:191], v[236:239]
    v_mfma_f32_16x16x32_bf16 v[232:235], v[60:63], v[184:187], v[232:235]
    v_mfma_f32_16x16x32_bf16 v[240:243], v[60:63], v[188:191], v[240:243]
    s_mov_b32 s20, 0xbdd2d3e8
    v_mov_b32 v20, 0xc0135761
    s_nop 2
    v_mul_f32 v24, v228, v228
    v_mul_f32 v25, v229, v229
    v_mul_f32 v26, v230, v230
    v_mul_f32 v27, v231, v231
    v_fma_f32 v24, v24, s20, v20
    v_fma_f32 v25, v25, s20, v20
    v_fma_f32 v26, v26, s20, v20
    v_fma_f32 v27, v27, s20, v20
    v_mul_f32 v24, v24, v228
    v_mul_f32 v25, v25, v229
    v_mul_f32 v26, v26, v230
    v_mul_f32 v27, v27, v231
    v_exp_f32 v24, v24
    v_exp_f32 v25, v25
    v_exp_f32 v26, v26
    v_exp_f32 v27, v27
    v_add_f32 v24, 1.0, v24
    v_add_f32 v25, 1.0, v25
    v_add_f32 v26, 1.0, v26
    v_add_f32 v27, 1.0, v27
    v_rcp_f32 v24, v24
    v_rcp_f32 v25, v25
    v_rcp_f32 v26, v26
    v_rcp_f32 v27, v27
    v_mul_f32 v228, v228, v24
    v_mul_f32 v229, v229, v25
    v_mul_f32 v230, v230, v26
    v_mul_f32 v231, v231, v27
    v_mul_f32 v24, v236, v236
    v_mul_f32 v25, v237, v237
    v_mul_f32 v26, v238, v238
    v_mul_f32 v27, v239, v239
    v_fma_f32 v24, v24, s20, v20
    v_fma_f32 v25, v25, s20, v20
    v_fma_f32 v26, v26, s20, v20
    v_fma_f32 v27, v27, s20, v20
    v_mul_f32 v24, v24, v236
    v_mul_f32 v25, v25, v237
    v_mul_f32 v26, v26, v238
    v_mul_f32 v27, v27, v239
    v_exp_f32 v24, v24
    v_exp_f32 v25, v25
    v_exp_f32 v26, v26
    v_exp_f32 v27, v27
    v_add_f32 v24, 1.0, v24
    v_add_f32 v25, 1.0, v25
    v_add_f32 v26, 1.0, v26
    v_add_f32 v27, 1.0, v27
    v_rcp_f32 v24, v24
    v_rcp_f32 v25, v25
    v_rcp_f32 v26, v26
    v_rcp_f32 v27, v27
    v_mul_f32 v236, v236, v24
    v_mul_f32 v237, v237, v25
    v_mul_f32 v238, v238, v26
    v_mul_f32 v239, v239, v27
    v_mul_f32 v24, v232, v232
    v_mul_f32 v25, v233, v233
    v_mul_f32 v26, v234, v234
    v_mul_f32 v27, v235, v235
    v_fma_f32 v24, v24, s20, v20
    v_fma_f32 v25, v25, s20, v20
    v_fma_f32 v26, v26, s20, v20
    v_fma_f32 v27, v27, s20, v20
    v_mul_f32 v24, v24, v232
    v_mul_f32 v25, v25, v233
    v_mul_f32 v26, v26, v234
    v_mul_f32 v27, v27, v235
    v_exp_f32 v24, v24
    v_exp_f32 v25, v25
    v_exp_f32 v26, v26
    v_exp_f32 v27, v27
    v_add_f32 v24, 1.0, v24
    v_add_f32 v25, 1.0, v25
    v_add_f32 v26, 1.0, v26
    v_add_f32 v27, 1.0, v27
    v_rcp_f32 v24, v24
    v_rcp_f32 v25, v25
    v_rcp_f32 v26, v26
    v_rcp_f32 v27, v27
    v_mul_f32 v232, v232, v24
    v_mul_f32 v233, v233, v25
    v_mul_f32 v234, v234, v26
    v_mul_f32 v235, v235, v27
    v_mul_f32 v24, v240, v240
    v_mul_f32 v25, v241, v241
    v_mul_f32 v26, v242, v242
    v_mul_f32 v27, v243, v243
    v_fma_f32 v24, v24, s20, v20
    v_fma_f32 v25, v25, s20, v20
    v_fma_f32 v26, v26, s20, v20
    v_fma_f32 v27, v27, s20, v20
    v_mul_f32 v24, v24, v240
    v_mul_f32 v25, v25, v241
    v_mul_f32 v26, v26, v242
    v_mul_f32 v27, v27, v243
    v_exp_f32 v24, v24
    v_exp_f32 v25, v25
    v_exp_f32 v26, v26
    v_exp_f32 v27, v27
    v_add_f32 v24, 1.0, v24
    v_add_f32 v25, 1.0, v25
    v_add_f32 v26, 1.0, v26
    v_add_f32 v27, 1.0, v27
    v_rcp_f32 v24, v24
    v_rcp_f32 v25, v25
    v_rcp_f32 v26, v26
    v_rcp_f32 v27, v27
    v_mul_f32 v240, v240, v24
    v_mul_f32 v241, v241, v25
    v_mul_f32 v242, v242, v26
    v_mul_f32 v243, v243, v27
    s_and_b32 s22, s3, 1
    s_mul_i32 s22, s22, 7168
    s_lshr_b32 s21, s3, 1
    s_lshl_b32 s21, s21, 10
    s_add_u32 s22, s22, s21
    s_add_u32 s22, s22, 135168
    v_lshlrev_b32 v7, 3, v1
    v_add_u32 v7, s22, v7
    v_cvt_pk_bf16_f32 v32, v228, v229
    v_cvt_pk_bf16_f32 v33, v230, v231
    ds_write_b64 v7, v[32:33] offset:0
    v_cvt_pk_bf16_f32 v34, v236, v237
    v_cvt_pk_bf16_f32 v35, v238, v239
    ds_write_b64 v7, v[34:35] offset:3584
    v_cvt_pk_bf16_f32 v36, v232, v233
    v_cvt_pk_bf16_f32 v37, v234, v235
    ds_write_b64 v7, v[36:37] offset:512
    v_cvt_pk_bf16_f32 v38, v240, v241
    v_cvt_pk_bf16_f32 v39, v242, v243
    ds_write_b64 v7, v[38:39] offset:4096
    s_cmp_lg_u32 s3, 0
    s_cbranch_scc1 win_nx_80
    v_lshlrev_b32 v5, 3, v1
    v_add_u32 v5, 155648, v5
    v_lshlrev_b32 v6, 4, v1
    s_lshl_b32 s20, s4, 13
    s_mov_b32 s47, 0
stp_81:
    s_add_u32 s21, s20, 0
    buffer_load_dwordx4 v[96:99], v6, s[36:39], s21 offen sc0 sc1
    s_add_u32 s21, s20, 1024
    buffer_load_dwordx4 v[100:103], v6, s[36:39], s21 offen sc0 sc1
    s_add_u32 s21, s20, 2048
    buffer_load_dwordx4 v[104:107], v6, s[36:39], s21 offen sc0 sc1
    s_add_u32 s21, s20, 3072
    buffer_load_dwordx4 v[108:111], v6, s[36:39], s21 offen sc0 sc1
    s_add_u32 s21, s20, 4096
    buffer_load_dwordx4 v[112:115], v6, s[36:39], s21 offen sc0 sc1
    s_add_u32 s21, s20, 5120
    buffer_load_dwordx4 v[116:119], v6, s[36:39], s21 offen sc0 sc1
    s_add_u32 s21, s20, 6144
    buffer_load_dwordx4 v[120:123], v6, s[36:39], s21 offen sc0 sc1
    s_add_u32 s21, s20, 7168
    buffer_load_dwordx4 v[124:127], v6, s[36:39], s21 offen sc0 sc1
    s_add_u32 s47, s47, 1
    s_cmp_gt_u32 s47, 1048576
    s_cbranch_scc1 std_82
    s_waitcnt vmcnt(0)
    s_mov_b64 s[42:43], -1
    v_cmp_eq_u32 vcc, s59, v98
    s_nop 3
    s_and_b64 s[42:43], s[42:43], vcc
    v_cmp_eq_u32 vcc, s59, v99
    s_nop 3
    s_and_b64 s[42:43], s[42:43], vcc
    v_cmp_eq_u32 vcc, s59, v102
    s_nop 3
    s_and_b64 s[42:43], s[42:43], vcc
    v_cmp_eq_u32 vcc, s59, v103
    s_nop 3
    s_and_b64 s[42:43], s[42:43], vcc
    v_cmp_eq_u32 vcc, s59, v106
    s_nop 3
    s_and_b64 s[42:43], s[42:43], vcc
    v_cmp_eq_u32 vcc, s59, v107
    s_nop 3
    s_and_b64 s[42:43], s[42:43], vcc
    v_cmp_eq_u32 vcc, s59, v110
    s_nop 3
    s_and_b64 s[42:43], s[42:43], vcc
    v_cmp_eq_u32 vcc, s59, v111
    s_nop 3
    s_and_b64 s[42:43], s[42:43], vcc
    v_cmp_eq_u32 vcc, s59, v114
    s_nop 3
    s_and_b64 s[42:43], s[42:43], vcc
    v_cmp_eq_u32 vcc, s59, v115
    s_nop 3
    s_and_b64 s[42:43], s[42:43], vcc
    v_cmp_eq_u32 vcc, s59, v118
    s_nop 3
    s_and_b64 s[42:43], s[42:43], vcc
    v_cmp_eq_u32 vcc, s59, v119
    s_nop 3
    s_and_b64 s[42:43], s[42:43], vcc
    v_cmp_eq_u32 vcc, s59, v122
    s_nop 3
    s_and_b64 s[42:43], s[42:43], vcc
    v_cmp_eq_u32 vcc, s59, v123
    s_nop 3
    s_and_b64 s[42:43], s[42:43], vcc
    v_cmp_eq_u32 vcc, s59, v126
    s_nop 3
    s_and_b64 s[42:43], s[42:43], vcc
    v_cmp_eq_u32 vcc, s59, v127
    s_nop 3
    s_and_b64 s[42:43], s[42:43], vcc
    s_cmp_eq_u64 s[42:43], -1
    s_cbranch_scc0 stp_81
std_82:
    s_waitcnt vmcnt(0)
    v_add_f32 v96, v96, v100
    v_add_f32 v97, v97, v101
    v_add_f32 v96, v96, v104
    v_add_f32 v97, v97, v105
    v_add_f32 v96, v96, v108
    v_add_f32 v97, v97, v109
    v_add_f32 v96, v96, v112
    v_add_f32 v97, v97, v113
    v_add_f32 v96, v96, v116
    v_add_f32 v97, v97, v117
    v_add_f32 v96, v96, v120
    v_add_f32 v97, v97, v121
    v_add_f32 v96, v96, v124
    v_add_f32 v97, v97, v125
    v_mul_f32 v96, 0x3a924925, v96
    v_mul_f32 v97, 0x3a924925, v97
    v_fma_f32 v97, -v96, v96, v97
    v_max_f32 v97, 0, v97
    v_add_f32 v97, 0x3727c5ac, v97
    v_rsq_f32 v99, v97
    s_nop 0
    v_mul_f32 v98, v96, v99
    v_sub_f32 v98, 0, v98
    ds_write_b64 v5, v[98:99] offset:2048
win_nx_80:
    s_waitcnt lgkmcnt(0)
    s_barrier
    v_lshrrev_b32 v3, 4, v1
    v_and_b32 v4, 15, v1
    s_and_b32 s20, s3, 1
    s_lshl_b32 s20, s20, 8
    s_add_u32 s20, s20, 157696
    v_lshlrev_b32 v5, 5, v3
    v_add_u32 v5, s20, v5
    ds_read_b128 v[64:67], v5 offset:0
    ds_read_b128 v[68:71], v5 offset:16
    ds_read_b128 v[72:75], v5 offset:128
    ds_read_b128 v[76:79], v5 offset:144
    v_and_b32 v6, 1, v3
    v_lshlrev_b32 v5, 9, v6
    v_lshrrev_b32 v6, 1, v3
    v_lshl_add_u32 v5, v6, 8, v5
    v_lshl_add_u32 v5, v4, 4, v5
    s_and_b32 s20, s3, 1
    s_lshl_b32 s21, s4, 1
    s_add_u32 s20, s20, s21
    s_lshl_b32 s20, s20, 10
    s_mul_i32 s21, s5, 7
    s_lshr_b32 s22, s3, 1
    s_lshl_b32 s22, s22, 1
    s_add_u32 s21, s21, s22
    s_lshl_b32 s21, s21, 16
    s_add_u32 s20, s20, s21
    s_waitcnt lgkmcnt(0)
    s_add_u32 s21, s20, 0
    v_fma_f32 v212, v212, v65, v64
    v_fma_f32 v213, v213, v67, v66
    v_fma_f32 v214, v214, v69, v68
    v_fma_f32 v215, v215, v71, v70
    v_cvt_pk_bf16_f32 v32, v212, v213
    v_cvt_pk_bf16_f32 v33, v214, v215
    v_fma_f32 v220, v220, v73, v72
    v_fma_f32 v221, v221, v75, v74
    v_fma_f32 v222, v222, v77, v76
    v_fma_f32 v223, v223, v79, v78
    v_cvt_pk_bf16_f32 v34, v220, v221
    v_cvt_pk_bf16_f32 v35, v222, v223
    s_nop 0
    v_permlane16_swap_b32 v32, v34
    v_permlane16_swap_b32 v33, v35
    buffer_store_dwordx4 v[32:35], v5, s[28:31], s21 offen sc1
    s_add_u32 s21, s20, 65536
    v_fma_f32 v216, v216, v65, v64
    v_fma_f32 v217, v217, v67, v66
    v_fma_f32 v218, v218, v69, v68
    v_fma_f32 v219, v219, v71, v70
    v_cvt_pk_bf16_f32 v36, v216, v217
    v_cvt_pk_bf16_f32 v37, v218, v219
    v_fma_f32 v224, v224, v73, v72
    v_fma_f32 v225, v225, v75, v74
    v_fma_f32 v226, v226, v77, v76
    v_fma_f32 v227, v227, v79, v78
    v_cvt_pk_bf16_f32 v38, v224, v225
    v_cvt_pk_bf16_f32 v39, v226, v227
    s_nop 0
    v_permlane16_swap_b32 v36, v38
    v_permlane16_swap_b32 v37, v39
    buffer_store_dwordx4 v[36:39], v5, s[28:31], s21 offen sc1
    s_branch win_join_78
win_v1_77:
    ds_read_b128 v[64:67], v208 offset:0
    ds_read_b128 v[68:71], v208 offset:16384
    ds_read_b64_tr_b16 v[32:33], v200 offset:0
    ds_read_b64_tr_b16 v[34:35], v200 offset:896
    ds_read_b128 v[72:75], v209 offset:0
    ds_read_b128 v[76:79], v209 offset:16384
    ds_read_b64_tr_b16 v[40:41], v200 offset:7168
    ds_read_b64_tr_b16 v[42:43], v200 offset:8064
    s_barrier
    s_waitcnt lgkmcnt(4)
    v_mfma_f32_16x16x32_bf16 v[212:215], v[64:67], v[32:35], v[212:215]
    ds_read_b128 v[80:83], v210 offset:0
    ds_read_b128 v[84:87], v210 offset:16384
    v_mfma_f32_16x16x32_bf16 v[220:223], v[68:71], v[32:35], v[220:223]
    ds_read_b64_tr_b16 v[48:49], v200 offset:14336
    ds_read_b64_tr_b16 v[50:51], v200 offset:15232
    s_waitcnt lgkmcnt(4)
    v_mfma_f32_16x16x32_bf16 v[212:215], v[72:75], v[40:43], v[212:215]
    ds_read_b128 v[88:91], v211 offset:0
    ds_read_b128 v[92:95], v211 offset:16384
    v_mfma_f32_16x16x32_bf16 v[220:223], v[76:79], v[40:43], v[220:223]
    ds_read_b64_tr_b16 v[56:57], v200 offset:21504
    ds_read_b64_tr_b16 v[58:59], v200 offset:22400
    s_add_u32 s23, s34, 1146880
    s_add_u32 m0, s7, 71680
    s_nop 0
    buffer_load_dwordx4 v192, s[16:19], s23 offen lds
    s_barrier
    s_waitcnt lgkmcnt(4)
    v_mfma_f32_16x16x32_bf16 v[212:215], v[80:83], v[48:51], v[212:215]
    ds_read_b128 v[96:99], v208 offset:256
    ds_read_b128 v[100:103], v208 offset:16640
    v_mfma_f32_16x16x32_bf16 v[220:223], v[84:87], v[48:51], v[220:223]
    ds_read_b64_tr_b16 v[32:33], v200 offset:28672
    ds_read_b64_tr_b16 v[34:35], v200 offset:29568
    s_waitcnt lgkmcnt(4)
    v_mfma_f32_16x16x32_bf16 v[212:215], v[88:91], v[56:59], v[212:215]
    ds_read_b128 v[104:107], v209 offset:256
    ds_read_b128 v[108:111], v209 offset:16640
    v_mfma_f32_16x16x32_bf16 v[220:223], v[92:95], v[56:59], v[220:223]
    ds_read_b64_tr_b16 v[40:41], v200 offset:35840
    ds_read_b64_tr_b16 v[42:43], v200 offset:36736
    s_add_u32 s23, s34, 1376256
    s_add_u32 m0, s7, 0
    s_nop 0
    buffer_load_dwordx4 v192, s[16:19], s23 offen lds
    s_barrier
    s_waitcnt lgkmcnt(4)
    v_mfma_f32_16x16x32_bf16 v[212:215], v[96:99], v[32:35], v[212:215]
    ds_read_b128 v[112:115], v210 offset:256
    ds_read_b128 v[116:119], v210 offset:16640
    v_mfma_f32_16x16x32_bf16 v[220:223], v[100:103], v[32:35], v[220:223]
    ds_read_b64_tr_b16 v[48:49], v200 offset:43008
    ds_read_b64_tr_b16 v[50:51], v200 offset:43904
    s_waitcnt lgkmcnt(4)
    v_mfma_f32_16x16x32_bf16 v[212:215], v[104:107], v[40:43], v[212:215]
    ds_read_b128 v[120:123], v211 offset:256
    ds_read_b128 v[124:127], v211 offset:16640
    v_mfma_f32_16x16x32_bf16 v[220:223], v[108:111], v[40:43], v[220:223]
    ds_read_b64_tr_b16 v[56:57], v200 offset:50176
    ds_read_b64_tr_b16 v[58:59], v200 offset:51072
    s_add_u32 s23, s34, 1605632
    s_add_u32 m0, s7, 14336
    s_nop 0
    buffer_load_dwordx4 v192, s[16:19], s23 offen lds
    s_barrier
    s_waitcnt lgkmcnt(4)
    v_mfma_f32_16x16x32_bf16 v[212:215], v[112:115], v[48:51], v[212:215]
    ds_read_b128 v[128:131], v208 offset:512
    ds_read_b128 v[132:135], v208 offset:16896
    v_mfma_f32_16x16x32_bf16 v[220:223], v[116:119], v[48:51], v[220:223]
    ds_read_b64_tr_b16 v[32:33], v202 offset:0
    ds_read_b64_tr_b16 v[34:35], v202 offset:896
    s_waitcnt lgkmcnt(4)
    v_mfma_f32_16x16x32_bf16 v[212:215], v[120:123], v[56:59], v[212:215]
    ds_read_b128 v[136:139], v209 offset:512
    ds_read_b128 v[140:143], v209 offset:16896
    v_mfma_f32_16x16x32_bf16 v[220:223], v[124:127], v[56:59], v[220:223]
    ds_read_b64_tr_b16 v[40:41], v202 offset:7168
    ds_read_b64_tr_b16 v[42:43], v202 offset:8064
    s_add_u32 s23, s33, 0
    s_add_u32 m0, s7, 28672
    s_nop 0
    buffer_load_dwordx4 v192, s[16:19], s23 offen lds
    s_waitcnt vmcnt(3)
    s_barrier
    s_waitcnt lgkmcnt(4)
    v_mfma_f32_16x16x32_bf16 v[212:215], v[128:131], v[32:35], v[212:215]
    ds_read_b128 v[144:147], v210 offset:512
    ds_read_b128 v[148:151], v210 offset:16896
    v_mfma_f32_16x16x32_bf16 v[220:223], v[132:135], v[32:35], v[220:223]
    ds_read_b64_tr_b16 v[48:49], v202 offset:14336
    ds_read_b64_tr_b16 v[50:51], v202 offset:15232
    s_waitcnt lgkmcnt(4)
    v_mfma_f32_16x16x32_bf16 v[212:215], v[136:139], v[40:43], v[212:215]
    ds_read_b128 v[152:155], v211 offset:512
    ds_read_b128 v[156:159], v211 offset:16896
    v_mfma_f32_16x16x32_bf16 v[220:223], v[140:143], v[40:43], v[220:223]
    ds_read_b64_tr_b16 v[56:57], v202 offset:21504
    ds_read_b64_tr_b16 v[58:59], v202 offset:22400
    s_add_u32 s23, s33, 229376
    s_add_u32 m0, s7, 43008
    s_nop 0
    buffer_load_dwordx4 v192, s[16:19], s23 offen lds
    s_waitcnt vmcnt(3)
    s_barrier
    s_waitcnt lgkmcnt(4)
    v_mfma_f32_16x16x32_bf16 v[212:215], v[144:147], v[48:51], v[212:215]
    ds_read_b128 v[160:163], v208 offset:768
    ds_read_b128 v[164:167], v208 offset:17152
    v_mfma_f32_16x16x32_bf16 v[220:223], v[148:151], v[48:51], v[220:223]
    ds_read_b64_tr_b16 v[32:33], v200 offset:0
    ds_read_b64_tr_b16 v[34:35], v200 offset:896
    s_waitcnt lgkmcnt(4)
    v_mfma_f32_16x16x32_bf16 v[212:215], v[152:155], v[56:59], v[212:215]
    ds_read_b128 v[168:171], v209 offset:768
    ds_read_b128 v[172:175], v209 offset:17152
    v_mfma_f32_16x16x32_bf16 v[220:223], v[156:159], v[56:59], v[220:223]
    ds_read_b64_tr_b16 v[40:41], v200 offset:7168
    ds_read_b64_tr_b16 v[42:43], v200 offset:8064
    s_add_u32 s23, s33, 458752
    s_add_u32 m0, s7, 57344
    s_nop 0
    buffer_load_dwordx4 v192, s[16:19], s23 offen lds
    s_waitcnt vmcnt(3)
    s_barrier
    s_waitcnt lgkmcnt(4)
    v_mfma_f32_16x16x32_bf16 v[212:215], v[160:163], v[32:35], v[212:215]
    ds_read_b128 v[176:179], v210 offset:768
    ds_read_b128 v[180:183], v210 offset:17152
    v_mfma_f32_16x16x32_bf16 v[220:223], v[164:167], v[32:35], v[220:223]
    ds_read_b64_tr_b16 v[48:49], v200 offset:14336
    ds_read_b64_tr_b16 v[50:51], v200 offset:15232
    s_waitcnt lgkmcnt(4)
    v_mfma_f32_16x16x32_bf16 v[212:215], v[168:171], v[40:43], v[212:215]
    ds_read_b128 v[184:187], v211 offset:768
    ds_read_b128 v[188:191], v211 offset:17152
    v_mfma_f32_16x16x32_bf16 v[220:223], v[172:175], v[40:43], v[220:223]
    ds_read_b64_tr_b16 v[56:57], v200 offset:21504
    ds_read_b64_tr_b16 v[58:59], v200 offset:22400
    s_add_u32 s23, s33, 688128
    s_add_u32 m0, s7, 71680
    s_nop 0
    buffer_load_dwordx4 v192, s[16:19], s23 offen lds
    s_waitcnt vmcnt(3)
    s_barrier
    s_waitcnt lgkmcnt(4)
    v_mfma_f32_16x16x32_bf16 v[212:215], v[176:179], v[48:51], v[212:215]
    ds_read_b64_tr_b16 v[32:33], v200 offset:28672
    ds_read_b64_tr_b16 v[34:35], v200 offset:29568
    v_mfma_f32_16x16x32_bf16 v[220:223], v[180:183], v[48:51], v[220:223]
    s_waitcnt lgkmcnt(2)
    v_mfma_f32_16x16x32_bf16 v[212:215], v[184:187], v[56:59], v[212:215]
    ds_read_b64_tr_b16 v[40:41], v200 offset:35840
    ds_read_b64_tr_b16 v[42:43], v200 offset:36736
    v_mfma_f32_16x16x32_bf16 v[220:223], v[188:191], v[56:59], v[220:223]
    s_add_u32 s23, s33, 917504
    s_add_u32 m0, s7, 0
    s_nop 0
    buffer_load_dwordx4 v192, s[16:19], s23 offen lds
    s_mov_b32 s20, 0xbdd2d3e8
    v_mov_b32 v20, 0xc0135761
    v_mul_f32 v24, v212, v212
    v_mul_f32 v25, v213, v213
    v_mul_f32 v26, v214, v214
    v_mul_f32 v27, v215, v215
    v_fma_f32 v24, v24, s20, v20
    v_fma_f32 v25, v25, s20, v20
    v_fma_f32 v26, v26, s20, v20
    v_fma_f32 v27, v27, s20, v20
    v_mul_f32 v24, v24, v212
    v_mul_f32 v25, v25, v213
    v_mul_f32 v26, v26, v214
    v_mul_f32 v27, v27, v215
    v_exp_f32 v24, v24
    v_exp_f32 v25, v25
    v_exp_f32 v26, v26
    v_exp_f32 v27, v27
    v_add_f32 v24, 1.0, v24
    v_add_f32 v25, 1.0, v25
    v_add_f32 v26, 1.0, v26
    v_add_f32 v27, 1.0, v27
    v_rcp_f32 v24, v24
    v_rcp_f32 v25, v25
    v_rcp_f32 v26, v26
    v_rcp_f32 v27, v27
    v_mul_f32 v212, v212, v24
    v_mul_f32 v213, v213, v25
    v_mul_f32 v214, v214, v26
    v_mul_f32 v215, v215, v27
    v_mul_f32 v24, v220, v220
    v_mul_f32 v25, v221, v221
    v_mul_f32 v26, v222, v222
    v_mul_f32 v27, v223, v223
    v_fma_f32 v24, v24, s20, v20
    v_fma_f32 v25, v25, s20, v20
    v_fma_f32 v26, v26, s20, v20
    v_fma_f32 v27, v27, s20, v20
    v_mul_f32 v24, v24, v220
    v_mul_f32 v25, v25, v221
    v_mul_f32 v26, v26, v222
    v_mul_f32 v27, v27, v223
    v_exp_f32 v24, v24
    v_exp_f32 v25, v25
    v_exp_f32 v26, v26
    v_exp_f32 v27, v27
    v_add_f32 v24, 1.0, v24
    v_add_f32 v25, 1.0, v25
    v_add_f32 v26, 1.0, v26
    v_add_f32 v27, 1.0, v27
    v_rcp_f32 v24, v24
    v_rcp_f32 v25, v25
    v_rcp_f32 v26, v26
    v_rcp_f32 v27, v27
    v_mul_f32 v220, v220, v24
    v_mul_f32 v221, v221, v25
    v_mul_f32 v222, v222, v26
    v_mul_f32 v223, v223, v27
    v_lshrrev_b32 v3, 4, v1
    v_and_b32 v4, 15, v1
    v_mov_b32 v8, v212
    v_mul_f32 v9, v212, v212
    v_mov_b32 v10, v213
    v_mul_f32 v11, v213, v213
    v_mov_b32 v12, v214
    v_mul_f32 v13, v214, v214
    v_mov_b32 v14, v215
    v_mul_f32 v15, v215, v215
    v_mov_b32 v16, v220
    v_mul_f32 v17, v220, v220
    v_mov_b32 v18, v221
    v_mul_f32 v19, v221, v221
    v_mov_b32 v28, v222
    v_mul_f32 v29, v222, v222
    v_mov_b32 v30, v223
    v_mul_f32 v31, v223, v223
    v_add_f32_dpp v8, v8, v8 quad_perm:[1,0,3,2] row_mask:0xf bank_mask:0xf
    v_add_f32_dpp v9, v9, v9 quad_perm:[1,0,3,2] row_mask:0xf bank_mask:0xf
    v_add_f32_dpp v10, v10, v10 quad_perm:[1,0,3,2] row_mask:0xf bank_mask:0xf
    v_add_f32_dpp v11, v11, v11 quad_perm:[1,0,3,2] row_mask:0xf bank_mask:0xf
    v_add_f32_dpp v12, v12, v12 quad_perm:[1,0,3,2] row_mask:0xf bank_mask:0xf
    v_add_f32_dpp v13, v13, v13 quad_perm:[1,0,3,2] row_mask:0xf bank_mask:0xf
    v_add_f32_dpp v14, v14, v14 quad_perm:[1,0,3,2] row_mask:0xf bank_mask:0xf
    v_add_f32_dpp v15, v15, v15 quad_perm:[1,0,3,2] row_mask:0xf bank_mask:0xf
    v_add_f32_dpp v16, v16, v16 quad_perm:[1,0,3,2] row_mask:0xf bank_mask:0xf
    v_add_f32_dpp v17, v17, v17 quad_perm:[1,0,3,2] row_mask:0xf bank_mask:0xf
    v_add_f32_dpp v18, v18, v18 quad_perm:[1,0,3,2] row_mask:0xf bank_mask:0xf
    v_add_f32_dpp v19, v19, v19 quad_perm:[1,0,3,2] row_mask:0xf bank_mask:0xf
    v_add_f32_dpp v28, v28, v28 quad_perm:[1,0,3,2] row_mask:0xf bank_mask:0xf
    v_add_f32_dpp v29, v29, v29 quad_perm:[1,0,3,2] row_mask:0xf bank_mask:0xf
    v_add_f32_dpp v30, v30, v30 quad_perm:[1,0,3,2] row_mask:0xf bank_mask:0xf
    v_add_f32_dpp v31, v31, v31 quad_perm:[1,0,3,2] row_mask:0xf bank_mask:0xf
    v_add_f32_dpp v8, v8, v8 quad_perm:[2,3,0,1] row_mask:0xf bank_mask:0xf
    v_add_f32_dpp v9, v9, v9 quad_perm:[2,3,0,1] row_mask:0xf bank_mask:0xf
    v_add_f32_dpp v10, v10, v10 quad_perm:[2,3,0,1] row_mask:0xf bank_mask:0xf
    v_add_f32_dpp v11, v11, v11 quad_perm:[2,3,0,1] row_mask:0xf bank_mask:0xf
    v_add_f32_dpp v12, v12, v12 quad_perm:[2,3,0,1] row_mask:0xf bank_mask:0xf
    v_add_f32_dpp v13, v13, v13 quad_perm:[2,3,0,1] row_mask:0xf bank_mask:0xf
    v_add_f32_dpp v14, v14, v14 quad_perm:[2,3,0,1] row_mask:0xf bank_mask:0xf
    v_add_f32_dpp v15, v15, v15 quad_perm:[2,3,0,1] row_mask:0xf bank_mask:0xf
    v_add_f32_dpp v16, v16, v16 quad_perm:[2,3,0,1] row_mask:0xf bank_mask:0xf
    v_add_f32_dpp v17, v17, v17 quad_perm:[2,3,0,1] row_mask:0xf bank_mask:0xf
    v_add_f32_dpp v18, v18, v18 quad_perm:[2,3,0,1] row_mask:0xf bank_mask:0xf
    v_add_f32_dpp v19, v19, v19 quad_perm:[2,3,0,1] row_mask:0xf bank_mask:0xf
    v_add_f32_dpp v28, v28, v28 quad_perm:[2,3,0,1] row_mask:0xf bank_mask:0xf
    v_add_f32_dpp v29, v29, v29 quad_perm:[2,3,0,1] row_mask:0xf bank_mask:0xf
    v_add_f32_dpp v30, v30, v30 quad_perm:[2,3,0,1] row_mask:0xf bank_mask:0xf
    v_add_f32_dpp v31, v31, v31 quad_perm:[2,3,0,1] row_mask:0xf bank_mask:0xf
    v_add_f32_dpp v8, v8, v8 row_half_mirror row_mask:0xf bank_mask:0xf
    v_add_f32_dpp v9, v9, v9 row_half_mirror row_mask:0xf bank_mask:0xf
    v_add_f32_dpp v10, v10, v10 row_half_mirror row_mask:0xf bank_mask:0xf
    v_add_f32_dpp v11, v11, v11 row_half_mirror row_mask:0xf bank_mask:0xf
    v_add_f32_dpp v12, v12, v12 row_half_mirror row_mask:0xf bank_mask:0xf
    v_add_f32_dpp v13, v13, v13 row_half_mirror row_mask:0xf bank_mask:0xf
    v_add_f32_dpp v14, v14, v14 row_half_mirror row_mask:0xf bank_mask:0xf
    v_add_f32_dpp v15, v15, v15 row_half_mirror row_mask:0xf bank_mask:0xf
    v_add_f32_dpp v16, v16, v16 row_half_mirror row_mask:0xf bank_mask:0xf
    v_add_f32_dpp v17, v17, v17 row_half_mirror row_mask:0xf bank_mask:0xf
    v_add_f32_dpp v18, v18, v18 row_half_mirror row_mask:0xf bank_mask:0xf
    v_add_f32_dpp v19, v19, v19 row_half_mirror row_mask:0xf bank_mask:0xf
    v_add_f32_dpp v28, v28, v28 row_half_mirror row_mask:0xf bank_mask:0xf
    v_add_f32_dpp v29, v29, v29 row_half_mirror row_mask:0xf bank_mask:0xf
    v_add_f32_dpp v30, v30, v30 row_half_mirror row_mask:0xf bank_mask:0xf
    v_add_f32_dpp v31, v31, v31 row_half_mirror row_mask:0xf bank_mask:0xf
    v_add_f32_dpp v8, v8, v8 row_mirror row_mask:0xf bank_mask:0xf
    v_add_f32_dpp v9, v9, v9 row_mirror row_mask:0xf bank_mask:0xf
    v_add_f32_dpp v10, v10, v10 row_mirror row_mask:0xf bank_mask:0xf
    v_add_f32_dpp v11, v11, v11 row_mirror row_mask:0xf bank_mask:0xf
    v_add_f32_dpp v12, v12, v12 row_mirror row_mask:0xf bank_mask:0xf
    v_add_f32_dpp v13, v13, v13 row_mirror row_mask:0xf bank_mask:0xf
    v_add_f32_dpp v14, v14, v14 row_mirror row_mask:0xf bank_mask:0xf
    v_add_f32_dpp v15, v15, v15 row_mirror row_mask:0xf bank_mask:0xf
    v_add_f32_dpp v16, v16, v16 row_mirror row_mask:0xf bank_mask:0xf
    v_add_f32_dpp v17, v17, v17 row_mirror row_mask:0xf bank_mask:0xf
    v_add_f32_dpp v18, v18, v18 row_mirror row_mask:0xf bank_mask:0xf
    v_add_f32_dpp v19, v19, v19 row_mirror row_mask:0xf bank_mask:0xf
    v_add_f32_dpp v28, v28, v28 row_mirror row_mask:0xf bank_mask:0xf
    v_add_f32_dpp v29, v29, v29 row_mirror row_mask:0xf bank_mask:0xf
    v_add_f32_dpp v30, v30, v30 row_mirror row_mask:0xf bank_mask:0xf
    v_add_f32_dpp v31, v31, v31 row_mirror row_mask:0xf bank_mask:0xf
    s_and_b32 s20, s3, 1
    s_lshl_b32 s20, s20, 8
    s_lshr_b32 s21, s3, 1
    s_lshl_b32 s21, s21, 9
    s_add_u32 s20, s20, s21
    s_add_u32 s20, s20, 155648
    v_lshlrev_b32 v5, 5, v3
    v_add_u32 v5, s20, v5
    v_cmp_eq_u32 vcc, 0, v4
    s_nop 3
    s_and_saveexec_b64 s[44:45], vcc
    ds_write_b64 v5, v[8:9] offset:0
    ds_write_b64 v5, v[10:11] offset:8
    ds_write_b64 v5, v[12:13] offset:16
    ds_write_b64 v5, v[14:15] offset:24
    ds_write_b64 v5, v[16:17] offset:128
    ds_write_b64 v5, v[18:19] offset:136
    ds_write_b64 v5, v[28:29] offset:144
    ds_write_b64 v5, v[30:31] offset:152
    s_mov_b64 exec, s[44:45]
    s_waitcnt lgkmcnt(0)
    s_waitcnt vmcnt(3)
    s_barrier
    s_waitcnt lgkmcnt(0)
    v_mfma_f32_16x16x32_bf16 v[228:231], v[32:35], v[64:67], v[228:231]
    ds_read_b64_tr_b16 v[48:49], v200 offset:43008
    ds_read_b64_tr_b16 v[50:51], v200 offset:43904
    v_mfma_f32_16x16x32_bf16 v[236:239], v[32:35], v[68:71], v[236:239]
    s_waitcnt lgkmcnt(2)
    v_mfma_f32_16x16x32_bf16 v[228:231], v[40:43], v[72:75], v[228:231]
    ds_read_b64_tr_b16 v[56:57], v200 offset:50176
    ds_read_b64_tr_b16 v[58:59], v200 offset:51072
    v_mfma_f32_16x16x32_bf16 v[236:239], v[40:43], v[76:79], v[236:239]
    s_add_u32 s23, s33, 1146880
    s_add_u32 m0, s7, 14336
    s_nop 0
    buffer_load_dwordx4 v192, s[16:19], s23 offen lds
    s_waitcnt vmcnt(3)
    s_barrier
    s_waitcnt lgkmcnt(2)
    v_mfma_f32_16x16x32_bf16 v[228:231], v[48:51], v[80:83], v[228:231]
    ds_read_b64_tr_b16 v[32:33], v202 offset:0
    ds_read_b64_tr_b16 v[34:35], v202 offset:896
    v_mfma_f32_16x16x32_bf16 v[236:239], v[48:51], v[84:87], v[236:239]
    s_waitcnt lgkmcnt(2)
    v_mfma_f32_16x16x32_bf16 v[228:231], v[56:59], v[88:91], v[228:231]
    ds_read_b64_tr_b16 v[40:41], v202 offset:7168
    ds_read_b64_tr_b16 v[42:43], v202 offset:8064
    v_mfma_f32_16x16x32_bf16 v[236:239], v[56:59], v[92:95], v[236:239]
    s_add_u32 s23, s33, 1376256
    s_add_u32 m0, s7, 28672
    s_nop 0
    buffer_load_dwordx4 v192, s[16:19], s23 offen lds
    s_waitcnt vmcnt(3)
    s_barrier
    s_waitcnt lgkmcnt(2)
    v_mfma_f32_16x16x32_bf16 v[228:231], v[32:35], v[96:99], v[228:231]
    ds_read_b64_tr_b16 v[48:49], v202 offset:14336
    ds_read_b64_tr_b16 v[50:51], v202 offset:15232
    v_mfma_f32_16x16x32_bf16 v[236:239], v[32:35], v[100:103], v[236:239]
    s_waitcnt lgkmcnt(2)
    v_mfma_f32_16x16x32_bf16 v[228:231], v[40:43], v[104:107], v[228:231]
    ds_read_b64_tr_b16 v[56:57], v202 offset:21504
    ds_read_b64_tr_b16 v[58:59], v202 offset:22400
    v_mfma_f32_16x16x32_bf16 v[236:239], v[40:43], v[108:111], v[236:239]
    s_add_u32 s23, s33, 1605632
    s_add_u32 m0, s7, 43008
    s_nop 0
    buffer_load_dwordx4 v192, s[16:19], s23 offen lds
    s_waitcnt vmcnt(3)
    s_barrier
    s_waitcnt lgkmcnt(2)
    v_mfma_f32_16x16x32_bf16 v[228:231], v[48:51], v[112:115], v[228:231]
    ds_read_b64_tr_b16 v[32:33], v200 offset:0
    ds_read_b64_tr_b16 v[34:35], v200 offset:896
    v_mfma_f32_16x16x32_bf16 v[236:239], v[48:51], v[116:119], v[236:239]
    s_waitcnt lgkmcnt(2)
    v_mfma_f32_16x16x32_bf16 v[228:231], v[56:59], v[120:123], v[228:231]
    ds_read_b64_tr_b16 v[40:41], v200 offset:7168
    ds_read_b64_tr_b16 v[42:43], v200 offset:8064
    v_mfma_f32_16x16x32_bf16 v[236:239], v[56:59], v[124:127], v[236:239]
    s_waitcnt vmcnt(2)
    s_barrier
    s_waitcnt lgkmcnt(2)
    v_mfma_f32_16x16x32_bf16 v[228:231], v[32:35], v[128:131], v[228:231]
    ds_read_b64_tr_b16 v[48:49], v200 offset:14336
    ds_read_b64_tr_b16 v[50:51], v200 offset:15232
    v_mfma_f32_16x16x32_bf16 v[236:239], v[32:35], v[132:135], v[236:239]
    s_waitcnt lgkmcnt(2)
    v_mfma_f32_16x16x32_bf16 v[228:231], v[40:43], v[136:139], v[228:231]
    ds_read_b64_tr_b16 v[56:57], v200 offset:21504
    ds_read_b64_tr_b16 v[58:59], v200 offset:22400
    v_mfma_f32_16x16x32_bf16 v[236:239], v[40:43], v[140:143], v[236:239]
    s_waitcnt vmcnt(1)
    s_barrier
    s_waitcnt lgkmcnt(2)
    v_mfma_f32_16x16x32_bf16 v[228:231], v[48:51], v[144:147], v[228:231]
    ds_read_b64_tr_b16 v[32:33], v200 offset:28672
    ds_read_b64_tr_b16 v[34:35], v200 offset:29568
    v_mfma_f32_16x16x32_bf16 v[236:239], v[48:51], v[148:151], v[236:239]
    s_waitcnt lgkmcnt(2)
    v_mfma_f32_16x16x32_bf16 v[228:231], v[56:59], v[152:155], v[228:231]
    ds_read_b64_tr_b16 v[40:41], v200 offset:35840
    ds_read_b64_tr_b16 v[42:43], v200 offset:36736
    v_mfma_f32_16x16x32_bf16 v[236:239], v[56:59], v[156:159], v[236:239]
    s_waitcnt vmcnt(0)
    s_barrier
    s_waitcnt lgkmcnt(2)
    v_mfma_f32_16x16x32_bf16 v[228:231], v[32:35], v[160:163], v[228:231]
    ds_read_b64_tr_b16 v[48:49], v200 offset:43008
    ds_read_b64_tr_b16 v[50:51], v200 offset:43904
    v_mfma_f32_16x16x32_bf16 v[236:239], v[32:35], v[164:167], v[236:239]
    s_waitcnt lgkmcnt(2)
    v_mfma_f32_16x16x32_bf16 v[228:231], v[40:43], v[168:171], v[228:231]
    ds_read_b64_tr_b16 v[56:57], v200 offset:50176
    ds_read_b64_tr_b16 v[58:59], v200 offset:51072
    v_mfma_f32_16x16x32_bf16 v[236:239], v[40:43], v[172:175], v[236:239]
    s_waitcnt lgkmcnt(2)
    v_mfma_f32_16x16x32_bf16 v[228:231], v[48:51], v[176:179], v[228:231]
    v_mfma_f32_16x16x32_bf16 v[236:239], v[48:51], v[180:183], v[236:239]
    s_waitcnt lgkmcnt(0)
    v_mfma_f32_16x16x32_bf16 v[228:231], v[56:59], v[184:187], v[228:231]
    v_mfma_f32_16x16x32_bf16 v[236:239], v[56:59], v[188:191], v[236:239]
    s_mov_b32 s20, 0xbdd2d3e8
    v_mov_b32 v20, 0xc0135761
    s_nop 4
    v_mul_f32 v24, v228, v228
    v_mul_f32 v25, v229, v229
    v_mul_f32 v26, v230, v230
    v_mul_f32 v27, v231, v231
    v_fma_f32 v24, v24, s20, v20
    v_fma_f32 v25, v25, s20, v20
    v_fma_f32 v26, v26, s20, v20
    v_fma_f32 v27, v27, s20, v20
    v_mul_f32 v24, v24, v228
    v_mul_f32 v25, v25, v229
    v_mul_f32 v26, v26, v230
    v_mul_f32 v27, v27, v231
    v_exp_f32 v24, v24
    v_exp_f32 v25, v25
    v_exp_f32 v26, v26
    v_exp_f32 v27, v27
    v_add_f32 v24, 1.0, v24
    v_add_f32 v25, 1.0, v25
    v_add_f32 v26, 1.0, v26
    v_add_f32 v27, 1.0, v27
    v_rcp_f32 v24, v24
    v_rcp_f32 v25, v25
    v_rcp_f32 v26, v26
    v_rcp_f32 v27, v27
    v_mul_f32 v228, v228, v24
    v_mul_f32 v229, v229, v25
    v_mul_f32 v230, v230, v26
    v_mul_f32 v231, v231, v27
    v_mul_f32 v24, v236, v236
    v_mul_f32 v25, v237, v237
    v_mul_f32 v26, v238, v238
    v_mul_f32 v27, v239, v239
    v_fma_f32 v24, v24, s20, v20
    v_fma_f32 v25, v25, s20, v20
    v_fma_f32 v26, v26, s20, v20
    v_fma_f32 v27, v27, s20, v20
    v_mul_f32 v24, v24, v236
    v_mul_f32 v25, v25, v237
    v_mul_f32 v26, v26, v238
    v_mul_f32 v27, v27, v239
    v_exp_f32 v24, v24
    v_exp_f32 v25, v25
    v_exp_f32 v26, v26
    v_exp_f32 v27, v27
    v_add_f32 v24, 1.0, v24
    v_add_f32 v25, 1.0, v25
    v_add_f32 v26, 1.0, v26
    v_add_f32 v27, 1.0, v27
    v_rcp_f32 v24, v24
    v_rcp_f32 v25, v25
    v_rcp_f32 v26, v26
    v_rcp_f32 v27, v27
    v_mul_f32 v236, v236, v24
    v_mul_f32 v237, v237, v25
    v_mul_f32 v238, v238, v26
    v_mul_f32 v239, v239, v27
    s_and_b32 s22, s3, 1
    s_mul_i32 s22, s22, 7168
    s_lshr_b32 s21, s3, 1
    s_lshl_b32 s21, s21, 10
    s_add_u32 s22, s22, s21
    s_add_u32 s22, s22, 135168
    v_lshlrev_b32 v7, 3, v1
    v_add_u32 v7, s22, v7
    v_cvt_pk_bf16_f32 v32, v228, v229
    v_cvt_pk_bf16_f32 v33, v230, v231
    ds_write_b64 v7, v[32:33] offset:0
    v_cvt_pk_bf16_f32 v34, v236, v237
    v_cvt_pk_bf16_f32 v35, v238, v239
    ds_write_b64 v7, v[34:35] offset:3584
    s_waitcnt lgkmcnt(0)
    s_barrier
    v_lshrrev_b32 v3, 4, v1
    v_and_b32 v4, 15, v1
    s_and_b32 s20, s3, 1
    s_lshl_b32 s20, s20, 8
    s_add_u32 s20, s20, 157696
    v_lshlrev_b32 v5, 5, v3
    v_add_u32 v5, s20, v5
    ds_read_b128 v[64:67], v5 offset:0
    ds_read_b128 v[68:71], v5 offset:16
    ds_read_b128 v[72:75], v5 offset:128
    ds_read_b128 v[76:79], v5 offset:144
    v_and_b32 v6, 1, v3
    v_lshlrev_b32 v5, 9, v6
    v_lshrrev_b32 v6, 1, v3
    v_lshl_add_u32 v5, v6, 8, v5
    v_lshl_add_u32 v5, v4, 4, v5
    s_and_b32 s20, s3, 1
    s_lshl_b32 s21, s4, 1
    s_add_u32 s20, s20, s21
    s_lshl_b32 s20, s20, 10
    s_mul_i32 s21, s5, 7
    s_lshr_b32 s22, s3, 1
    s_lshl_b32 s22, s22, 1
    s_add_u32 s21, s21, s22
    s_lshl_b32 s21, s21, 16
    s_add_u32 s20, s20, s21
    s_waitcnt lgkmcnt(0)
    s_add_u32 s21, s20, 0
    v_fma_f32 v212, v212, v65, v64
    v_fma_f32 v213, v213, v67, v66
    v_fma_f32 v214, v214, v69, v68
    v_fma_f32 v215, v215, v71, v70
    v_cvt_pk_bf16_f32 v32, v212, v213
    v_cvt_pk_bf16_f32 v33, v214, v215
    v_fma_f32 v220, v220, v73, v72
    v_fma_f32 v221, v221, v75, v74
    v_fma_f32 v222, v222, v77, v76
    v_fma_f32 v223, v223, v79, v78
    v_cvt_pk_bf16_f32 v34, v220, v221
    v_cvt_pk_bf16_f32 v35, v222, v223
    s_nop 0
    v_permlane16_swap_b32 v32, v34
    v_permlane16_swap_b32 v33, v35
    buffer_store_dwordx4 v[32:35], v5, s[28:31], s21 offen sc1
win_join_78:
    s_waitcnt vmcnt(0) lgkmcnt(0)
    s_barrier
    s_cmp_lg_u32 s3, 7
    s_cbranch_scc1 sig_83
    s_lshl_b32 s46, s5, 7
    s_lshl_b32 s47, s4, 2
    s_add_u32 s46, s46, s47
    s_add_u32 s46, s46, 24576
    v_mov_b32 v250, s59
    v_mul_u32_u24 v251, 1, v1
    s_mov_b64 exec, 1
    buffer_store_dword v250, v251, s[60:63], s46 offen sc1
    s_mov_b64 exec, -1
sig_83:
    s_mov_b32 s8, s74
    s_mov_b32 s9, s75
    s_mov_b32 s10, 0x800000
    s_mov_b32 s11, 0x20000
    s_add_u32 s12, s88, 0x1300000
    s_addc_u32 s13, s89, 0
    s_mov_b32 s14, 0x380000
    s_mov_b32 s15, 0x20000
    s_add_u32 s24, s88, 0x1700000
    s_addc_u32 s25, s89, 0
    s_mov_b32 s26, 0x380000
    s_mov_b32 s27, 0x20000
    s_mov_b32 s28, s76
    s_mov_b32 s29, s77
    s_mov_b32 s30, 0x1000
    s_mov_b32 s31, 0x20000
    s_mov_b32 s44, 4294832128
    s_mov_b32 s45, 22528
    v_lshlrev_b32 v2, 4, v1
    v_lshrrev_b32 v3, 4, v1
    v_and_b32 v4, 15, v1
    s_cmp_ge_u32 s3, 4
    s_cbranch_scc1 sp_prod_85
    s_and_b32 s20, s3, 1
    s_lshl_b32 s21, s4, 2
    s_lshl_b32 s22, s20, 1
    s_add_u32 s21, s21, s22
    v_lshlrev_b32 v5, 1, v4
    s_lshl_b32 s22, s21, 5
    buffer_load_ushort v20, v5, s[28:31], s22 offen
    buffer_load_ushort v21, v5, s[28:31], s22 offen offset:32
    s_bfe_u32 s23, s3, 0x10001
    s_lshl_b32 s23, s23, 2
    v_lshrrev_b32 v7, 1, v3
    v_lshlrev_b32 v7, 9, v7
    v_lshl_add_u32 v7, v4, 4, v7
    v_and_b32 v8, 1, v3
    v_lshl_add_u32 v7, v8, 3, v7
    s_lshl_b32 s21, s4, 1
    s_add_u32 s21, s21, s20
    s_mul_i32 s21, s21, 56
    s_mul_i32 s6, s5, 7
    s_add_u32 s21, s21, s6
    s_add_u32 s21, s21, s23
    s_lshl_b32 s35, s21, 10
    s_mul_i32 s6, s20, 7168
    s_lshl_b32 s21, s23, 9
    s_add_u32 s6, s6, s21
    s_add_u32 s6, s6, 135168
    v_lshlrev_b32 v9, 3, v1
    v_add_u32 v9, s6, v9
    s_and_b32 s20, s3, 1
    s_lshl_b32 s20, s20, 12
    v_lshlrev_b32 v5, 7, v4
    v_add_u32 v5, s20, v5
    v_lshrrev_b32 v8, 1, v4
    v_add_u32 v6, 0, v3
    v_xor_b32 v6, v6, v8
    v_lshl_add_u32 v200, v6, 4, v5
    v_add_u32 v6, 4, v3
    v_xor_b32 v6, v6, v8
    v_lshl_add_u32 v201, v6, 4, v5
    s_bfe_u32 s20, s3, 0x10001
    s_lshl_b32 s20, s20, 13
    s_add_u32 s20, s20, 8192
    v_add_u32 v202, s20, v2
    ds_read_b64 v[176:177], v9 offset:0
    ds_read_b64 v[178:179], v9 offset:512
    ds_read_b64 v[180:181], v9 offset:1024
    ds_read_b64 v[182:183], v9 offset:1536
    ds_read_b64 v[184:185], v9 offset:3584
    ds_read_b64 v[186:187], v9 offset:4096
    ds_read_b64 v[188:189], v9 offset:4608
    ds_read_b64 v[190:191], v9 offset:5120
    s_waitcnt lgkmcnt(0)
    v_mov_b32 v128, 0
    v_mov_b32 v129, 0
    v_mov_b32 v130, 0
    v_mov_b32 v131, 0
    v_mov_b32 v132, 0
    v_mov_b32 v133, 0
    v_mov_b32 v134, 0
    v_mov_b32 v135, 0
    v_mov_b32 v136, 0
    v_mov_b32 v137, 0
    v_mov_b32 v138, 0
    v_mov_b32 v139, 0
    v_mov_b32 v140, 0
    v_mov_b32 v141, 0
    v_mov_b32 v142, 0
    v_mov_b32 v143, 0
    v_mov_b32 v144, 0
    v_mov_b32 v145, 0
    v_mov_b32 v146, 0
    v_mov_b32 v147, 0
    v_mov_b32 v148, 0
    v_mov_b32 v149, 0
    v_mov_b32 v150, 0
    v_mov_b32 v151, 0
    v_mov_b32 v152, 0
    v_mov_b32 v153, 0
    v_mov_b32 v154, 0
    v_mov_b32 v155, 0
    v_mov_b32 v156, 0
    v_mov_b32 v157, 0
    v_mov_b32 v158, 0
    v_mov_b32 v159, 0
    s_barrier
    s_barrier
    s_bitcmp1_b32 s3, 1
    s_cbranch_scc1 sp_3_86
    ds_read_b128 v[32:35], v200 offset:0
    ds_read_b128 v[36:39], v200 offset:2048
    ds_read_b128 v[40:43], v202 offset:0
    ds_read_b128 v[44:47], v202 offset:2048
    ds_read_b128 v[48:51], v202 offset:4096
    ds_read_b128 v[52:55], v202 offset:6144
    s_mov_b32 s36, 0
    s_mov_b32 s37, 22528
    s_mov_b32 s38, 1
sp_loop_88:
    s_barrier
    v_add_u32 v203, s37, v200
    v_add_u32 v204, s37, v201
    v_add_u32 v205, s37, v202
    s_waitcnt lgkmcnt(0)
    v_mfma_f32_16x16x32_bf16 v[128:131], v[40:43], v[32:35], v[128:131]
    ds_read_b128 v[56:59], v201 offset:0
    ds_read_b128 v[60:63], v201 offset:2048
    v_mfma_f32_16x16x32_bf16 v[144:147], v[40:43], v[36:39], v[144:147]
    ds_read_b128 v[64:67], v202 offset:1024
    ds_read_b128 v[68:71], v202 offset:3072
    v_mfma_f32_16x16x32_bf16 v[132:135], v[44:47], v[32:35], v[132:135]
    ds_read_b128 v[72:75], v202 offset:5120
    ds_read_b128 v[76:79], v202 offset:7168
    v_mfma_f32_16x16x32_bf16 v[148:151], v[44:47], v[36:39], v[148:151]
    v_mfma_f32_16x16x32_bf16 v[136:139], v[48:51], v[32:35], v[136:139]
    v_mfma_f32_16x16x32_bf16 v[152:155], v[48:51], v[36:39], v[152:155]
    v_mfma_f32_16x16x32_bf16 v[140:143], v[52:55], v[32:35], v[140:143]
    v_mfma_f32_16x16x32_bf16 v[156:159], v[52:55], v[36:39], v[156:159]
    s_waitcnt lgkmcnt(0)
    v_mfma_f32_16x16x32_bf16 v[128:131], v[64:67], v[56:59], v[128:131]
    ds_read_b128 v[32:35], v203 offset:0
    ds_read_b128 v[36:39], v203 offset:2048
    v_mfma_f32_16x16x32_bf16 v[144:147], v[64:67], v[60:63], v[144:147]
    ds_read_b128 v[40:43], v205 offset:0
    ds_read_b128 v[44:47], v205 offset:2048
    v_mfma_f32_16x16x32_bf16 v[132:135], v[68:71], v[56:59], v[132:135]
    ds_read_b128 v[48:51], v205 offset:4096
    ds_read_b128 v[52:55], v205 offset:6144
    v_mfma_f32_16x16x32_bf16 v[148:151], v[68:71], v[60:63], v[148:151]
    v_mfma_f32_16x16x32_bf16 v[136:139], v[72:75], v[56:59], v[136:139]
    v_mfma_f32_16x16x32_bf16 v[152:155], v[72:75], v[60:63], v[152:155]
    v_mfma_f32_16x16x32_bf16 v[140:143], v[76:79], v[56:59], v[140:143]
    v_mfma_f32_16x16x32_bf16 v[156:159], v[76:79], v[60:63], v[156:159]
    v_mov_b32 v200, v203
    v_mov_b32 v201, v204
    v_mov_b32 v202, v205
    s_add_u32 s38, s38, 1
    s_cmp_eq_u32 s38, 7
    s_cselect_b32 s37, s44, s45
    s_cselect_b32 s38, 0, s38
    s_add_u32 s36, s36, 1
    s_cmp_lt_u32 s36, 32
    s_cbranch_scc1 sp_loop_88
    s_branch sp_epi_87
sp_3_86:
    ds_read_b128 v[32:35], v200 offset:0
    ds_read_b128 v[36:39], v200 offset:2048
    ds_read_b128 v[40:43], v202 offset:0
    ds_read_b128 v[44:47], v202 offset:2048
    ds_read_b128 v[48:51], v202 offset:4096
    s_mov_b32 s36, 0
    s_mov_b32 s37, 22528
    s_mov_b32 s38, 1
sp_loop_89:
    s_barrier
    v_add_u32 v203, s37, v200
    v_add_u32 v204, s37, v201
    v_add_u32 v205, s37, v202
    s_waitcnt lgkmcnt(0)
    v_mfma_f32_16x16x32_bf16 v[128:131], v[40:43], v[32:35], v[128:131]
    ds_read_b128 v[56:59], v201 offset:0
    ds_read_b128 v[60:63], v201 offset:2048
    v_mfma_f32_16x16x32_bf16 v[144:147], v[40:43], v[36:39], v[144:147]
    ds_read_b128 v[64:67], v202 offset:1024
    ds_read_b128 v[68:71], v202 offset:3072
    v_mfma_f32_16x16x32_bf16 v[132:135], v[44:47], v[32:35], v[132:135]
    ds_read_b128 v[72:75], v202 offset:5120
    v_mfma_f32_16x16x32_bf16 v[148:151], v[44:47], v[36:39], v[148:151]
    v_mfma_f32_16x16x32_bf16 v[136:139], v[48:51], v[32:35], v[136:139]
    v_mfma_f32_16x16x32_bf16 v[152:155], v[48:51], v[36:39], v[152:155]
    s_waitcnt lgkmcnt(0)
    v_mfma_f32_16x16x32_bf16 v[128:131], v[64:67], v[56:59], v[128:131]
    ds_read_b128 v[32:35], v203 offset:0
    ds_read_b128 v[36:39], v203 offset:2048
    v_mfma_f32_16x16x32_bf16 v[144:147], v[64:67], v[60:63], v[144:147]
    ds_read_b128 v[40:43], v205 offset:0
    ds_read_b128 v[44:47], v205 offset:2048
    v_mfma_f32_16x16x32_bf16 v[132:135], v[68:71], v[56:59], v[132:135]
    ds_read_b128 v[48:51], v205 offset:4096
    v_mfma_f32_16x16x32_bf16 v[148:151], v[68:71], v[60:63], v[148:151]
    v_mfma_f32_16x16x32_bf16 v[136:139], v[72:75], v[56:59], v[136:139]
    v_mfma_f32_16x16x32_bf16 v[152:155], v[72:75], v[60:63], v[152:155]
    v_mov_b32 v200, v203
    v_mov_b32 v201, v204
    v_mov_b32 v202, v205
    s_add_u32 s38, s38, 1
    s_cmp_eq_u32 s38, 7
    s_cselect_b32 s37, s44, s45
    s_cselect_b32 s38, 0, s38
    s_add_u32 s36, s36, 1
    s_cmp_lt_u32 s36, 32
    s_cbranch_scc1 sp_loop_89
sp_epi_87:
    s_waitcnt vmcnt(0) lgkmcnt(0)
    v_lshlrev_b32 v20, 16, v20
    v_lshlrev_b32 v21, 16, v21
    v_lshlrev_b32 v22, 16, v176
    v_and_b32 v23, 0xffff0000, v176
    v_add_f32 v24, v128, v20
    v_add_f32 v25, v129, v20
    v_mul_f32 v22, v22, v24
    v_mul_f32 v23, v23, v25
    v_cvt_pk_bf16_f32 v32, v22, v23
    v_lshlrev_b32 v22, 16, v177
    v_and_b32 v23, 0xffff0000, v177
    v_add_f32 v24, v130, v20
    v_add_f32 v25, v131, v20
    v_mul_f32 v22, v22, v24
    v_mul_f32 v23, v23, v25
    v_cvt_pk_bf16_f32 v33, v22, v23
    v_lshlrev_b32 v22, 16, v184
    v_and_b32 v23, 0xffff0000, v184
    v_add_f32 v24, v144, v21
    v_add_f32 v25, v145, v21
    v_mul_f32 v22, v22, v24
    v_mul_f32 v23, v23, v25
    v_cvt_pk_bf16_f32 v34, v22, v23
    v_lshlrev_b32 v22, 16, v185
    v_and_b32 v23, 0xffff0000, v185
    v_add_f32 v24, v146, v21
    v_add_f32 v25, v147, v21
    v_mul_f32 v22, v22, v24
    v_mul_f32 v23, v23, v25
    v_cvt_pk_bf16_f32 v35, v22, v23
    v_permlane16_swap_b32 v32, v34
    s_nop 0
    v_permlane16_swap_b32 v33, v35
    buffer_store_dwordx4 v[32:35], v2, s[24:27], s35 offen offset:0 sc1
    v_lshlrev_b32 v22, 16, v178
    v_and_b32 v23, 0xffff0000, v178
    v_add_f32 v24, v132, v20
    v_add_f32 v25, v133, v20
    v_mul_f32 v22, v22, v24
    v_mul_f32 v23, v23, v25
    v_cvt_pk_bf16_f32 v36, v22, v23
    v_lshlrev_b32 v22, 16, v179
    v_and_b32 v23, 0xffff0000, v179
    v_add_f32 v24, v134, v20
    v_add_f32 v25, v135, v20
    v_mul_f32 v22, v22, v24
    v_mul_f32 v23, v23, v25
    v_cvt_pk_bf16_f32 v37, v22, v23
    v_lshlrev_b32 v22, 16, v186
    v_and_b32 v23, 0xffff0000, v186
    v_add_f32 v24, v148, v21
    v_add_f32 v25, v149, v21
    v_mul_f32 v22, v22, v24
    v_mul_f32 v23, v23, v25
    v_cvt_pk_bf16_f32 v38, v22, v23
    v_lshlrev_b32 v22, 16, v187
    v_and_b32 v23, 0xffff0000, v187
    v_add_f32 v24, v150, v21
    v_add_f32 v25, v151, v21
    v_mul_f32 v22, v22, v24
    v_mul_f32 v23, v23, v25
    v_cvt_pk_bf16_f32 v39, v22, v23
    v_permlane16_swap_b32 v36, v38
    s_nop 0
    v_permlane16_swap_b32 v37, v39
    buffer_store_dwordx4 v[36:39], v2, s[24:27], s35 offen offset:1024 sc1
    v_lshlrev_b32 v22, 16, v180
    v_and_b32 v23, 0xffff0000, v180
    v_add_f32 v24, v136, v20
    v_add_f32 v25, v137, v20
    v_mul_f32 v22, v22, v24
    v_mul_f32 v23, v23, v25
    v_cvt_pk_bf16_f32 v40, v22, v23
    v_lshlrev_b32 v22, 16, v181
    v_and_b32 v23, 0xffff0000, v181
    v_add_f32 v24, v138, v20
    v_add_f32 v25, v139, v20
    v_mul_f32 v22, v22, v24
    v_mul_f32 v23, v23, v25
    v_cvt_pk_bf16_f32 v41, v22, v23
    v_lshlrev_b32 v22, 16, v188
    v_and_b32 v23, 0xffff0000, v188
    v_add_f32 v24, v152, v21
    v_add_f32 v25, v153, v21
    v_mul_f32 v22, v22, v24
    v_mul_f32 v23, v23, v25
    v_cvt_pk_bf16_f32 v42, v22, v23
    v_lshlrev_b32 v22, 16, v189
    v_and_b32 v23, 0xffff0000, v189
    v_add_f32 v24, v154, v21
    v_add_f32 v25, v155, v21
    v_mul_f32 v22, v22, v24
    v_mul_f32 v23, v23, v25
    v_cvt_pk_bf16_f32 v43, v22, v23
    v_permlane16_swap_b32 v40, v42
    s_nop 0
    v_permlane16_swap_b32 v41, v43
    buffer_store_dwordx4 v[40:43], v2, s[24:27], s35 offen offset:2048 sc1
    s_bitcmp1_b32 s3, 1
    s_cbranch_scc1 sp_end_84
    v_lshlrev_b32 v22, 16, v182
    v_and_b32 v23, 0xffff0000, v182
    v_add_f32 v24, v140, v20
    v_add_f32 v25, v141, v20
    v_mul_f32 v22, v22, v24
    v_mul_f32 v23, v23, v25
    v_cvt_pk_bf16_f32 v44, v22, v23
    v_lshlrev_b32 v22, 16, v183
    v_and_b32 v23, 0xffff0000, v183
    v_add_f32 v24, v142, v20
    v_add_f32 v25, v143, v20
    v_mul_f32 v22, v22, v24
    v_mul_f32 v23, v23, v25
    v_cvt_pk_bf16_f32 v45, v22, v23
    v_lshlrev_b32 v22, 16, v190
    v_and_b32 v23, 0xffff0000, v190
    v_add_f32 v24, v156, v21
    v_add_f32 v25, v157, v21
    v_mul_f32 v22, v22, v24
    v_mul_f32 v23, v23, v25
    v_cvt_pk_bf16_f32 v46, v22, v23
    v_lshlrev_b32 v22, 16, v191
    v_and_b32 v23, 0xffff0000, v191
    v_add_f32 v24, v158, v21
    v_add_f32 v25, v159, v21
    v_mul_f32 v22, v22, v24
    v_mul_f32 v23, v23, v25
    v_cvt_pk_bf16_f32 v47, v22, v23
    v_permlane16_swap_b32 v44, v46
    s_nop 0
    v_permlane16_swap_b32 v45, v47
    buffer_store_dwordx4 v[44:47], v2, s[24:27], s35 offen offset:3072 sc1
    s_branch sp_end_84
sp_prod_85:
    s_and_b32 s7, s3, 3
    v_lshrrev_b32 v5, 3, v1
    v_and_b32 v6, 7, v1
    s_lshl_b32 s20, s7, 3
    s_add_u32 s20, s20, 0
    v_add_u32 v8, s20, v5
    v_bfe_u32 v9, v8, 1, 3
    v_xor_b32 v9, v9, v6
    v_lshlrev_b32 v8, 12, v8
    v_lshl_add_u32 v192, v9, 4, v8
    s_lshl_b32 s20, s7, 3
    s_add_u32 s20, s20, 32
    v_add_u32 v8, s20, v5
    v_bfe_u32 v9, v8, 1, 3
    v_xor_b32 v9, v9, v6
    v_lshlrev_b32 v8, 12, v8
    v_lshl_add_u32 v193, v9, 4, v8
    s_lshl_b32 s6, s4, 18
    s_mul_i32 s32, s5, 0x70000
    s_lshr_b32 s20, s7, 1
    s_lshl_b32 s20, s20, 16
    s_add_u32 s32, s32, s20
    s_and_b32 s20, s7, 1
    s_lshl_b32 s20, s20, 10
    s_add_u32 s32, s32, s20
    s_lshl_b32 s33, s7, 10
    s_mov_b32 s34, s33
    s_cmp_eq_u32 s3, 7
    s_cbranch_scc1 wf7_91
    s_add_u32 m0, s34, 0
    s_nop 0
    buffer_load_dwordx4 v192, s[8:11], s6 offen lds
    s_add_u32 m0, s34, 4096
    s_nop 0
    buffer_load_dwordx4 v193, s[8:11], s6 offen lds
    s_add_u32 s6, s6, 128
    s_add_u32 m0, s34, 22528
    s_nop 0
    buffer_load_dwordx4 v192, s[8:11], s6 offen lds
    s_add_u32 m0, s34, 26624
    s_nop 0
    buffer_load_dwordx4 v193, s[8:11], s6 offen lds
    s_add_u32 s6, s6, 128
    s_add_u32 m0, s34, 45056
    s_nop 0
    buffer_load_dwordx4 v192, s[8:11], s6 offen lds
    s_add_u32 m0, s34, 49152
    s_nop 0
    buffer_load_dwordx4 v193, s[8:11], s6 offen lds
    s_add_u32 s6, s6, 128
    s_add_u32 m0, s34, 67584
    s_nop 0
    buffer_load_dwordx4 v192, s[8:11], s6 offen lds
    s_add_u32 m0, s34, 71680
    s_nop 0
    buffer_load_dwordx4 v193, s[8:11], s6 offen lds
    s_add_u32 s6, s6, 128
    s_add_u32 m0, s34, 90112
    s_nop 0
    buffer_load_dwordx4 v192, s[8:11], s6 offen lds
    s_add_u32 m0, s34, 94208
    s_nop 0
    buffer_load_dwordx4 v193, s[8:11], s6 offen lds
    s_add_u32 s6, s6, 128
    s_add_u32 m0, s34, 112640
    s_nop 0
    buffer_load_dwordx4 v192, s[8:11], s6 offen lds
    s_add_u32 m0, s34, 116736
    s_nop 0
    buffer_load_dwordx4 v193, s[8:11], s6 offen lds
    s_add_u32 s6, s6, 128
    s_branch wf_90
wf7_91:
    s_lshl_b32 s46, s5, 7
    s_add_u32 s46, s46, 24576
    v_lshlrev_b32 v251, 2, v1
    s_mov_b32 s42, 0xffffffff
    s_mov_b32 s43, 0x0
    s_mov_b32 s47, 0
poll_92:
    buffer_load_dword v250, v251, s[60:63], s46 offen sc0 sc1
    s_add_u32 s47, s47, 1
    s_cmp_gt_u32 s47, 1048576
    s_cbranch_scc1 polled_93
    s_waitcnt vmcnt(0)
    v_cmp_eq_u32 vcc, s59, v250
    s_nop 3
    s_and_b64 vcc, vcc, s[42:43]
    s_cmp_eq_u64 vcc, s[42:43]
    s_cbranch_scc0 poll_92
polled_93:
    s_add_u32 m0, s34, 0
    s_nop 0
    buffer_load_dwordx4 v192, s[8:11], s6 offen lds
    s_add_u32 m0, s34, 4096
    s_nop 0
    buffer_load_dwordx4 v193, s[8:11], s6 offen lds
    s_add_u32 s6, s6, 128
    s_add_u32 m0, s34, 22528
    s_nop 0
    buffer_load_dwordx4 v192, s[8:11], s6 offen lds
    s_add_u32 m0, s34, 26624
    s_nop 0
    buffer_load_dwordx4 v193, s[8:11], s6 offen lds
    s_add_u32 s6, s6, 128
    s_add_u32 m0, s34, 45056
    s_nop 0
    buffer_load_dwordx4 v192, s[8:11], s6 offen lds
    s_add_u32 m0, s34, 49152
    s_nop 0
    buffer_load_dwordx4 v193, s[8:11], s6 offen lds
    s_add_u32 s6, s6, 128
    s_add_u32 m0, s34, 67584
    s_nop 0
    buffer_load_dwordx4 v192, s[8:11], s6 offen lds
    s_add_u32 m0, s34, 71680
    s_nop 0
    buffer_load_dwordx4 v193, s[8:11], s6 offen lds
    s_add_u32 s6, s6, 128
    s_add_u32 m0, s34, 90112
    s_nop 0
    buffer_load_dwordx4 v192, s[8:11], s6 offen lds
    s_add_u32 m0, s34, 94208
    s_nop 0
    buffer_load_dwordx4 v193, s[8:11], s6 offen lds
    s_add_u32 s6, s6, 128
    s_add_u32 m0, s34, 112640
    s_nop 0
    buffer_load_dwordx4 v192, s[8:11], s6 offen lds
    s_add_u32 m0, s34, 116736
    s_nop 0
    buffer_load_dwordx4 v193, s[8:11], s6 offen lds
    s_add_u32 s6, s6, 128
wf_90:
    s_barrier
    s_cmp_ge_u32 s7, 2
    s_cbranch_scc1 sp_p5_94
    s_add_u32 s23, s32, 0
    s_add_u32 m0, s34, 8192
    s_nop 0
    buffer_load_dwordx4 v2, s[12:15], s23 offen lds
    s_add_u32 s23, s32, 131072
    s_add_u32 m0, s34, 12288
    s_nop 0
    buffer_load_dwordx4 v2, s[12:15], s23 offen lds
    s_add_u32 s23, s32, 262144
    s_add_u32 m0, s34, 16384
    s_nop 0
    buffer_load_dwordx4 v2, s[12:15], s23 offen lds
    s_add_u32 s23, s32, 393216
    s_add_u32 m0, s34, 20480
    s_nop 0
    buffer_load_dwordx4 v2, s[12:15], s23 offen lds
    s_add_u32 s32, s32, 2048
    s_add_u32 s34, s34, 22528
    s_add_u32 s23, s32, 0
    s_add_u32 m0, s34, 8192
    s_nop 0
    buffer_load_dwordx4 v2, s[12:15], s23 offen lds
    s_add_u32 s23, s32, 131072
    s_add_u32 m0, s34, 12288
    s_nop 0
    buffer_load_dwordx4 v2, s[12:15], s23 offen lds
    s_add_u32 s23, s32, 262144
    s_add_u32 m0, s34, 16384
    s_nop 0
    buffer_load_dwordx4 v2, s[12:15], s23 offen lds
    s_add_u32 s23, s32, 393216
    s_add_u32 m0, s34, 20480
    s_nop 0
    buffer_load_dwordx4 v2, s[12:15], s23 offen lds
    s_add_u32 s32, s32, 2048
    s_add_u32 s34, s34, 22528
    s_add_u32 s23, s32, 0
    s_add_u32 m0, s34, 8192
    s_nop 0
    buffer_load_dwordx4 v2, s[12:15], s23 offen lds
    s_add_u32 s23, s32, 131072
    s_add_u32 m0, s34, 12288
    s_nop 0
    buffer_load_dwordx4 v2, s[12:15], s23 offen lds
    s_add_u32 s23, s32, 262144
    s_add_u32 m0, s34, 16384
    s_nop 0
    buffer_load_dwordx4 v2, s[12:15], s23 offen lds
    s_add_u32 s23, s32, 393216
    s_add_u32 m0, s34, 20480
    s_nop 0
    buffer_load_dwordx4 v2, s[12:15], s23 offen lds
    s_add_u32 s32, s32, 2048
    s_add_u32 s34, s34, 22528
    s_add_u32 s23, s32, 0
    s_add_u32 m0, s34, 8192
    s_nop 0
    buffer_load_dwordx4 v2, s[12:15], s23 offen lds
    s_add_u32 s23, s32, 131072
    s_add_u32 m0, s34, 12288
    s_nop 0
    buffer_load_dwordx4 v2, s[12:15], s23 offen lds
    s_add_u32 s23, s32, 262144
    s_add_u32 m0, s34, 16384
    s_nop 0
    buffer_load_dwordx4 v2, s[12:15], s23 offen lds
    s_add_u32 s23, s32, 393216
    s_add_u32 m0, s34, 20480
    s_nop 0
    buffer_load_dwordx4 v2, s[12:15], s23 offen lds
    s_add_u32 s32, s32, 2048
    s_add_u32 s34, s34, 22528
    s_add_u32 s23, s32, 0
    s_add_u32 m0, s34, 8192
    s_nop 0
    buffer_load_dwordx4 v2, s[12:15], s23 offen lds
    s_add_u32 s23, s32, 131072
    s_add_u32 m0, s34, 12288
    s_nop 0
    buffer_load_dwordx4 v2, s[12:15], s23 offen lds
    s_add_u32 s23, s32, 262144
    s_add_u32 m0, s34, 16384
    s_nop 0
    buffer_load_dwordx4 v2, s[12:15], s23 offen lds
    s_add_u32 s23, s32, 393216
    s_add_u32 m0, s34, 20480
    s_nop 0
    buffer_load_dwordx4 v2, s[12:15], s23 offen lds
    s_add_u32 s32, s32, 2048
    s_add_u32 s34, s34, 22528
    s_add_u32 s23, s32, 0
    s_add_u32 m0, s34, 8192
    s_nop 0
    buffer_load_dwordx4 v2, s[12:15], s23 offen lds
    s_add_u32 s23, s32, 131072
    s_add_u32 m0, s34, 12288
    s_nop 0
    buffer_load_dwordx4 v2, s[12:15], s23 offen lds
    s_add_u32 s23, s32, 262144
    s_add_u32 m0, s34, 16384
    s_nop 0
    buffer_load_dwordx4 v2, s[12:15], s23 offen lds
    s_add_u32 s23, s32, 393216
    s_add_u32 m0, s34, 20480
    s_nop 0
    buffer_load_dwordx4 v2, s[12:15], s23 offen lds
    s_add_u32 s32, s32, 2048
    s_add_u32 s34, s34, 22528
    s_waitcnt vmcnt(20)
    s_barrier
    s_mov_b32 s36, 0
    s_mov_b32 s38, 6
sp_ploop_95:
    s_cmp_ge_u32 s36, 27
    s_cbranch_scc1 sp_w_97
    s_cmp_lt_u32 s36, 4
    s_cbranch_scc1 sp_e_98
    s_waitcnt vmcnt(24)
    s_branch sp_b_99
sp_e_98:
    s_waitcnt vmcnt(16)
sp_b_99:
    s_barrier
    s_cmp_ge_u32 s36, 26
    s_cbranch_scc1 sp_ni_96
    s_add_u32 m0, s34, 0
    s_nop 0
    buffer_load_dwordx4 v192, s[8:11], s6 offen lds
    s_add_u32 m0, s34, 4096
    s_nop 0
    buffer_load_dwordx4 v193, s[8:11], s6 offen lds
    s_add_u32 s6, s6, 128
    s_add_u32 s23, s32, 0
    s_add_u32 m0, s34, 8192
    s_nop 0
    buffer_load_dwordx4 v2, s[12:15], s23 offen lds
    s_add_u32 s23, s32, 131072
    s_add_u32 m0, s34, 12288
    s_nop 0
    buffer_load_dwordx4 v2, s[12:15], s23 offen lds
    s_add_u32 s23, s32, 262144
    s_add_u32 m0, s34, 16384
    s_nop 0
    buffer_load_dwordx4 v2, s[12:15], s23 offen lds
    s_add_u32 s23, s32, 393216
    s_add_u32 m0, s34, 20480
    s_nop 0
    buffer_load_dwordx4 v2, s[12:15], s23 offen lds
    s_add_u32 s32, s32, 2048
    s_add_u32 s38, s38, 1
    s_cmp_eq_u32 s38, 7
    s_cselect_b32 s39, s44, s45
    s_cselect_b32 s38, 0, s38
    s_add_u32 s34, s34, s39
    s_branch sp_ni_96
sp_w_97:
    s_waitcnt vmcnt(0)
    s_barrier
sp_ni_96:
    s_add_u32 s36, s36, 1
    s_cmp_lt_u32 s36, 32
    s_cbranch_scc1 sp_ploop_95
    s_branch sp_end_84
sp_p5_94:
    s_add_u32 s23, s32, 0
    s_add_u32 m0, s34, 8192
    s_nop 0
    buffer_load_dwordx4 v2, s[12:15], s23 offen lds
    s_add_u32 s23, s32, 131072
    s_add_u32 m0, s34, 12288
    s_nop 0
    buffer_load_dwordx4 v2, s[12:15], s23 offen lds
    s_add_u32 s23, s32, 262144
    s_add_u32 m0, s34, 16384
    s_nop 0
    buffer_load_dwordx4 v2, s[12:15], s23 offen lds
    s_add_u32 s32, s32, 2048
    s_add_u32 s34, s34, 22528
    s_add_u32 s23, s32, 0
    s_add_u32 m0, s34, 8192
    s_nop 0
    buffer_load_dwordx4 v2, s[12:15], s23 offen lds
    s_add_u32 s23, s32, 131072
    s_add_u32 m0, s34, 12288
    s_nop 0
    buffer_load_dwordx4 v2, s[12:15], s23 offen lds
    s_add_u32 s23, s32, 262144
    s_add_u32 m0, s34, 16384
    s_nop 0
    buffer_load_dwordx4 v2, s[12:15], s23 offen lds
    s_add_u32 s32, s32, 2048
    s_add_u32 s34, s34, 22528
    s_add_u32 s23, s32, 0
    s_add_u32 m0, s34, 8192
    s_nop 0
    buffer_load_dwordx4 v2, s[12:15], s23 offen lds
    s_add_u32 s23, s32, 131072
    s_add_u32 m0, s34, 12288
    s_nop 0
    buffer_load_dwordx4 v2, s[12:15], s23 offen lds
    s_add_u32 s23, s32, 262144
    s_add_u32 m0, s34, 16384
    s_nop 0
    buffer_load_dwordx4 v2, s[12:15], s23 offen lds
    s_add_u32 s32, s32, 2048
    s_add_u32 s34, s34, 22528
    s_add_u32 s23, s32, 0
    s_add_u32 m0, s34, 8192
    s_nop 0
    buffer_load_dwordx4 v2, s[12:15], s23 offen lds
    s_add_u32 s23, s32, 131072
    s_add_u32 m0, s34, 12288
    s_nop 0
    buffer_load_dwordx4 v2, s[12:15], s23 offen lds
    s_add_u32 s23, s32, 262144
    s_add_u32 m0, s34, 16384
    s_nop 0
    buffer_load_dwordx4 v2, s[12:15], s23 offen lds
    s_add_u32 s32, s32, 2048
    s_add_u32 s34, s34, 22528
    s_add_u32 s23, s32, 0
    s_add_u32 m0, s34, 8192
    s_nop 0
    buffer_load_dwordx4 v2, s[12:15], s23 offen lds
    s_add_u32 s23, s32, 131072
    s_add_u32 m0, s34, 12288
    s_nop 0
    buffer_load_dwordx4 v2, s[12:15], s23 offen lds
    s_add_u32 s23, s32, 262144
    s_add_u32 m0, s34, 16384
    s_nop 0
    buffer_load_dwordx4 v2, s[12:15], s23 offen lds
    s_add_u32 s32, s32, 2048
    s_add_u32 s34, s34, 22528
    s_add_u32 s23, s32, 0
    s_add_u32 m0, s34, 8192
    s_nop 0
    buffer_load_dwordx4 v2, s[12:15], s23 offen lds
    s_add_u32 s23, s32, 131072
    s_add_u32 m0, s34, 12288
    s_nop 0
    buffer_load_dwordx4 v2, s[12:15], s23 offen lds
    s_add_u32 s23, s32, 262144
    s_add_u32 m0, s34, 16384
    s_nop 0
    buffer_load_dwordx4 v2, s[12:15], s23 offen lds
    s_add_u32 s32, s32, 2048
    s_add_u32 s34, s34, 22528
    s_waitcnt vmcnt(15)
    s_barrier
    s_mov_b32 s36, 0
    s_mov_b32 s38, 6
sp_ploop_100:
    s_cmp_ge_u32 s36, 27
    s_cbranch_scc1 sp_w_102
    s_cmp_lt_u32 s36, 4
    s_cbranch_scc1 sp_e_103
    s_waitcnt vmcnt(20)
    s_branch sp_b_104
sp_e_103:
    s_waitcnt vmcnt(12)
sp_b_104:
    s_barrier
    s_cmp_ge_u32 s36, 26
    s_cbranch_scc1 sp_ni_101
    s_add_u32 m0, s34, 0
    s_nop 0
    buffer_load_dwordx4 v192, s[8:11], s6 offen lds
    s_add_u32 m0, s34, 4096
    s_nop 0
    buffer_load_dwordx4 v193, s[8:11], s6 offen lds
    s_add_u32 s6, s6, 128
    s_add_u32 s23, s32, 0
    s_add_u32 m0, s34, 8192
    s_nop 0
    buffer_load_dwordx4 v2, s[12:15], s23 offen lds
    s_add_u32 s23, s32, 131072
    s_add_u32 m0, s34, 12288
    s_nop 0
    buffer_load_dwordx4 v2, s[12:15], s23 offen lds
    s_add_u32 s23, s32, 262144
    s_add_u32 m0, s34, 16384
    s_nop 0
    buffer_load_dwordx4 v2, s[12:15], s23 offen lds
    s_add_u32 s32, s32, 2048
    s_add_u32 s38, s38, 1
    s_cmp_eq_u32 s38, 7
    s_cselect_b32 s39, s44, s45
    s_cselect_b32 s38, 0, s38
    s_add_u32 s34, s34, s39
    s_branch sp_ni_101
sp_w_102:
    s_waitcnt vmcnt(0)
    s_barrier
sp_ni_101:
    s_add_u32 s36, s36, 1
    s_cmp_lt_u32 s36, 32
    s_cbranch_scc1 sp_ploop_100
sp_end_84:
    s_waitcnt vmcnt(0) lgkmcnt(0)
    s_barrier
    s_cmp_lg_u32 s3, 7
    s_cbranch_scc1 sig_105
    s_lshl_b32 s46, s4, 7
    s_lshl_b32 s47, s5, 2
    s_add_u32 s46, s46, s47
    s_add_u32 s46, s46, 28672
    v_mov_b32 v250, s59
    v_mul_u32_u24 v251, 1, v1
    s_mov_b64 exec, 1
    buffer_store_dword v250, v251, s[60:63], s46 offen sc1
    s_mov_b64 exec, -1
sig_105:
    s_add_u32 s8, s88, 0x1700000
    s_addc_u32 s9, s89, 0
    s_mov_b32 s10, 0x380000
    s_mov_b32 s11, 0x20000
    s_mov_b32 s12, s78
    s_mov_b32 s13, s79
    s_mov_b32 s14, 0xe0000
    s_mov_b32 s15, 0x20000
    s_add_u32 s16, s88, 0x900000
    s_addc_u32 s17, s89, 0
    s_mov_b32 s18, 0x200000
    s_mov_b32 s19, 0x20000
    s_mov_b32 s24, s84
    s_mov_b32 s25, s85
    s_mov_b32 s26, 0x200000
    s_mov_b32 s27, 0x20000
    s_mov_b32 s28, s88
    s_mov_b32 s29, s89
    s_mov_b32 s30, 0xc000
    s_mov_b32 s31, 0x20000
    v_lshlrev_b32 v2, 4, v1
    v_lshrrev_b32 v3, 3, v1
    v_and_b32 v4, 7, v1
    v_bfe_u32 v5, v3, 1, 1
    v_lshlrev_b32 v5, 2, v5
    v_xor_b32 v4, v4, v5
    v_lshlrev_b32 v3, 10, v3
    v_lshl_add_u32 v3, v4, 4, v3
    s_lshl_b32 s20, s5, 7
    v_add_u32 v3, s20, v3
    s_and_b32 s20, s3, 1
    s_lshl_b32 s20, s20, 13
    s_lshr_b32 s21, s3, 2
    s_lshl_b32 s22, s21, 12
    s_add_u32 s20, s20, s22
    s_add_u32 s20, s20, 114688
    v_add_u32 v8, s20, v2
    v_lshrrev_b32 v4, 4, v1
    v_and_b32 v5, 15, v1
    v_lshrrev_b32 v6, 2, v5
    v_and_b32 v7, 3, v5
    v_lshrrev_b32 v10, 1, v4
    v_and_b32 v11, 1, v4
    v_lshl_add_u32 v12, v10, 3, v6
    v_lshlrev_b32 v12, 7, v12
    v_bfe_u32 v13, v6, 1, 1
    s_bfe_u32 s20, s3, 0x10001
    v_xor_b32 v13, s20, v13
    v_lshl_add_u32 v12, v13, 6, v12
    v_lshl_add_u32 v12, v11, 5, v12
    v_lshl_add_u32 v12, v7, 3, v12
    s_lshl_b32 s22, s21, 13
    s_add_u32 s22, s22, 0
    v_add_u32 v9, s22, v12
    v_add_u32 v10, 0x10000, v9
    v_lshrrev_b32 v14, 2, v1
    v_and_b32 v15, 3, v1
    s_and_b32 s20, s3, 1
    s_lshl_b32 s20, s20, 5
    s_lshl_b32 s21, s4, 6
    s_add_u32 s20, s20, s21
    s_lshr_b32 s21, s3, 2
    s_lshl_b32 s21, s21, 4
    s_add_u32 s36, s20, s21
    v_add_u32 v16, s36, v14
    v_lshlrev_b32 v16, 10, v16
    v_lshl_add_u32 v16, v15, 4, v16
    s_bfe_u32 s20, s3, 0x10001
    s_lshl_b32 s20, s20, 6
    s_lshl_b32 s21, s5, 7
    s_add_u32 s32, s20, s21
    v_lshlrev_b32 v17, 5, v15
    s_lshl_b32 s33, s32, 1
    s_cmp_eq_u32 s3, 7
    s_cbranch_scc1 wf7_107
    s_add_u32 s21, s3, 0
    s_lshl_b32 s20, s21, 13
    s_lshl_b32 s21, s21, 10
    s_mov_b32 m0, s21
    s_nop 0
    buffer_load_dwordx4 v3, s[12:15], s20 offen lds
    s_add_u32 s21, s3, 7
    s_lshl_b32 s20, s21, 13
    s_lshl_b32 s21, s21, 10
    s_mov_b32 m0, s21
    s_nop 0
    buffer_load_dwordx4 v3, s[12:15], s20 offen lds
    s_add_u32 s21, s3, 14
    s_lshl_b32 s20, s21, 13
    s_lshl_b32 s21, s21, 10
    s_mov_b32 m0, s21
    s_nop 0
    buffer_load_dwordx4 v3, s[12:15], s20 offen lds
    s_add_u32 s21, s3, 21
    s_lshl_b32 s20, s21, 13
    s_lshl_b32 s21, s21, 10
    s_mov_b32 m0, s21
    s_nop 0
    buffer_load_dwordx4 v3, s[12:15], s20 offen lds
    s_add_u32 s21, s3, 28
    s_lshl_b32 s20, s21, 13
    s_lshl_b32 s21, s21, 10
    s_mov_b32 m0, s21
    s_nop 0
    buffer_load_dwordx4 v3, s[12:15], s20 offen lds
    s_add_u32 s21, s3, 35
    s_lshl_b32 s20, s21, 13
    s_lshl_b32 s21, s21, 10
    s_mov_b32 m0, s21
    s_nop 0
    buffer_load_dwordx4 v3, s[12:15], s20 offen lds
    s_add_u32 s21, s3, 42
    s_lshl_b32 s20, s21, 13
    s_lshl_b32 s21, s21, 10
    s_mov_b32 m0, s21
    s_nop 0
    buffer_load_dwordx4 v3, s[12:15], s20 offen lds
    s_add_u32 s21, s3, 49
    s_lshl_b32 s20, s21, 13
    s_lshl_b32 s21, s21, 10
    s_mov_b32 m0, s21
    s_nop 0
    buffer_load_dwordx4 v3, s[12:15], s20 offen lds
    s_add_u32 s21, s3, 56
    s_lshl_b32 s20, s21, 13
    s_lshl_b32 s21, s21, 10
    s_mov_b32 m0, s21
    s_nop 0
    buffer_load_dwordx4 v3, s[12:15], s20 offen lds
    s_add_u32 s21, s3, 63
    s_lshl_b32 s20, s21, 13
    s_lshl_b32 s21, s21, 10
    s_mov_b32 m0, s21
    s_nop 0
    buffer_load_dwordx4 v3, s[12:15], s20 offen lds
    s_add_u32 s21, s3, 70
    s_lshl_b32 s20, s21, 13
    s_lshl_b32 s21, s21, 10
    s_mov_b32 m0, s21
    s_nop 0
    buffer_load_dwordx4 v3, s[12:15], s20 offen lds
    s_add_u32 s21, s3, 77
    s_lshl_b32 s20, s21, 13
    s_lshl_b32 s21, s21, 10
    s_mov_b32 m0, s21
    s_nop 0
    buffer_load_dwordx4 v3, s[12:15], s20 offen lds
    s_add_u32 s21, s3, 84
    s_lshl_b32 s20, s21, 13
    s_lshl_b32 s21, s21, 10
    s_mov_b32 m0, s21
    s_nop 0
    buffer_load_dwordx4 v3, s[12:15], s20 offen lds
    s_add_u32 s21, s3, 91
    s_lshl_b32 s20, s21, 13
    s_lshl_b32 s21, s21, 10
    s_mov_b32 m0, s21
    s_nop 0
    buffer_load_dwordx4 v3, s[12:15], s20 offen lds
    s_add_u32 s21, s3, 98
    s_lshl_b32 s20, s21, 13
    s_lshl_b32 s21, s21, 10
    s_mov_b32 m0, s21
    s_nop 0
    buffer_load_dwordx4 v3, s[12:15], s20 offen lds
    s_add_u32 s21, s3, 105
    s_lshl_b32 s20, s21, 13
    s_lshl_b32 s21, s21, 10
    s_mov_b32 m0, s21
    s_nop 0
    buffer_load_dwordx4 v3, s[12:15], s20 offen lds
    s_branch wf_106
wf7_107:
    s_lshl_b32 s46, s4, 7
    s_add_u32 s46, s46, 28672
    v_lshlrev_b32 v251, 2, v1
    s_mov_b32 s42, 0xff
    s_mov_b32 s43, 0x0
    s_mov_b32 s47, 0
poll_108:
    buffer_load_dword v250, v251, s[60:63], s46 offen sc0 sc1
    s_add_u32 s47, s47, 1
    s_cmp_gt_u32 s47, 1048576
    s_cbranch_scc1 polled_109
    s_waitcnt vmcnt(0)
    v_cmp_eq_u32 vcc, s59, v250
    s_nop 3
    s_and_b64 vcc, vcc, s[42:43]
    s_cmp_eq_u64 vcc, s[42:43]
    s_cbranch_scc0 poll_108
polled_109:
wf_106:
    s_barrier
    s_mul_i32 s6, s4, 114688
    s_lshl_b32 s21, s3, 10
    s_add_u32 s6, s6, s21
    s_add_u32 s20, s6, 0
    s_add_u32 m0, s21, 114688
    s_nop 0
    buffer_load_dwordx4 v2, s[8:11], s20 offen lds
    s_add_u32 s20, s6, 57344
    s_add_u32 m0, s21, 122880
    s_nop 0
    buffer_load_dwordx4 v2, s[8:11], s20 offen lds
    s_barrier
    s_add_u32 s20, s6, 8192
    s_add_u32 m0, s21, 131072
    s_nop 0
    buffer_load_dwordx4 v2, s[8:11], s20 offen lds
    s_add_u32 s20, s6, 65536
    s_add_u32 m0, s21, 139264
    s_nop 0
    buffer_load_dwordx4 v2, s[8:11], s20 offen lds
    s_barrier
    s_add_u32 s20, s6, 16384
    s_add_u32 m0, s21, 147456
    s_nop 0
    buffer_load_dwordx4 v2, s[8:11], s20 offen lds
    s_add_u32 s20, s6, 73728
    s_add_u32 m0, s21, 155648
    s_nop 0
    buffer_load_dwordx4 v2, s[8:11], s20 offen lds
    buffer_load_dwordx4 v[32:35], v16, s[16:19], s32 offen
    s_add_u32 s20, s33, 10240
    buffer_load_dwordx4 v[160:163], v17, s[28:31], s20 offen offset:0
    buffer_load_dwordx4 v[164:167], v17, s[28:31], s20 offen offset:16
    s_add_u32 s20, s33, 22528
    buffer_load_dwordx4 v[168:171], v17, s[28:31], s20 offen offset:0
    buffer_load_dwordx4 v[172:175], v17, s[28:31], s20 offen offset:16
    s_add_u32 s20, s33, 34816
    buffer_load_dwordx4 v[176:179], v17, s[28:31], s20 offen offset:0
    buffer_load_dwordx4 v[180:183], v17, s[28:31], s20 offen offset:16
    s_add_u32 s20, s33, 47104
    buffer_load_dwordx4 v[184:187], v17, s[28:31], s20 offen offset:0
    buffer_load_dwordx4 v[188:191], v17, s[28:31], s20 offen offset:16
    v_mov_b32 v64, 0
    v_mov_b32 v65, 0
    v_mov_b32 v66, 0
    v_mov_b32 v67, 0
    v_mov_b32 v68, 0
    v_mov_b32 v69, 0
    v_mov_b32 v70, 0
    v_mov_b32 v71, 0
    v_mov_b32 v72, 0
    v_mov_b32 v73, 0
    v_mov_b32 v74, 0
    v_mov_b32 v75, 0
    v_mov_b32 v76, 0
    v_mov_b32 v77, 0
    v_mov_b32 v78, 0
    v_mov_b32 v79, 0
    s_waitcnt vmcnt(13)
    s_barrier
    ds_read_b128 v[96:99], v8 offset:0
    ds_read_b64_tr_b16 v[100:101], v9 offset:0
    ds_read_b64_tr_b16 v[102:103], v9 offset:512
    ds_read_b128 v[104:107], v8 offset:1024
    ds_read_b64_tr_b16 v[108:109], v9 offset:2048
    ds_read_b64_tr_b16 v[110:111], v9 offset:2560
    ds_read_b128 v[112:115], v8 offset:2048
    ds_read_b64_tr_b16 v[116:117], v9 offset:4096
    ds_read_b64_tr_b16 v[118:119], v9 offset:4608
    ds_read_b128 v[120:123], v8 offset:3072
    ds_read_b64_tr_b16 v[124:125], v9 offset:6144
    ds_read_b64_tr_b16 v[126:127], v9 offset:6656
    s_waitcnt lgkmcnt(9)
    v_mfma_f32_32x32x16_bf16 v[64:79], v[100:103], v[96:99], v[64:79]
    s_waitcnt lgkmcnt(6)
    v_mfma_f32_32x32x16_bf16 v[64:79], v[108:111], v[104:107], v[64:79]
    s_waitcnt lgkmcnt(3)
    v_mfma_f32_32x32x16_bf16 v[64:79], v[116:119], v[112:115], v[64:79]
    s_waitcnt lgkmcnt(0)
    v_mfma_f32_32x32x16_bf16 v[64:79], v[124:127], v[120:123], v[64:79]
    s_waitcnt vmcnt(11)
    s_barrier
    s_add_u32 s20, s6, 24576
    s_add_u32 m0, s21, 114688
    s_nop 0
    buffer_load_dwordx4 v2, s[8:11], s20 offen lds
    s_add_u32 s20, s6, 81920
    s_add_u32 m0, s21, 122880
    s_nop 0
    buffer_load_dwordx4 v2, s[8:11], s20 offen lds
    ds_read_b128 v[96:99], v8 offset:16384
    ds_read_b64_tr_b16 v[100:101], v9 offset:16384
    ds_read_b64_tr_b16 v[102:103], v9 offset:16896
    ds_read_b128 v[104:107], v8 offset:17408
    ds_read_b64_tr_b16 v[108:109], v9 offset:18432
    ds_read_b64_tr_b16 v[110:111], v9 offset:18944
    ds_read_b128 v[112:115], v8 offset:18432
    ds_read_b64_tr_b16 v[116:117], v9 offset:20480
    ds_read_b64_tr_b16 v[118:119], v9 offset:20992
    ds_read_b128 v[120:123], v8 offset:19456
    ds_read_b64_tr_b16 v[124:125], v9 offset:22528
    ds_read_b64_tr_b16 v[126:127], v9 offset:23040
    s_waitcnt lgkmcnt(9)
    v_mfma_f32_32x32x16_bf16 v[64:79], v[100:103], v[96:99], v[64:79]
    s_waitcnt lgkmcnt(6)
    v_mfma_f32_32x32x16_bf16 v[64:79], v[108:111], v[104:107], v[64:79]
    s_waitcnt lgkmcnt(3)
    v_mfma_f32_32x32x16_bf16 v[64:79], v[116:119], v[112:115], v[64:79]
    s_waitcnt lgkmcnt(0)
    v_mfma_f32_32x32x16_bf16 v[64:79], v[124:127], v[120:123], v[64:79]
    s_waitcnt vmcnt(11)
    s_barrier
    s_add_u32 s20, s6, 32768
    s_add_u32 m0, s21, 131072
    s_nop 0
    buffer_load_dwordx4 v2, s[8:11], s20 offen lds
    s_add_u32 s20, s6, 90112
    s_add_u32 m0, s21, 139264
    s_nop 0
    buffer_load_dwordx4 v2, s[8:11], s20 offen lds
    ds_read_b128 v[96:99], v8 offset:32768
    ds_read_b64_tr_b16 v[100:101], v9 offset:32768
    ds_read_b64_tr_b16 v[102:103], v9 offset:33280
    ds_read_b128 v[104:107], v8 offset:33792
    ds_read_b64_tr_b16 v[108:109], v9 offset:34816
    ds_read_b64_tr_b16 v[110:111], v9 offset:35328
    ds_read_b128 v[112:115], v8 offset:34816
    ds_read_b64_tr_b16 v[116:117], v9 offset:36864
    ds_read_b64_tr_b16 v[118:119], v9 offset:37376
    ds_read_b128 v[120:123], v8 offset:35840
    ds_read_b64_tr_b16 v[124:125], v9 offset:38912
    ds_read_b64_tr_b16 v[126:127], v9 offset:39424
    s_waitcnt lgkmcnt(9)
    v_mfma_f32_32x32x16_bf16 v[64:79], v[100:103], v[96:99], v[64:79]
    s_waitcnt lgkmcnt(6)
    v_mfma_f32_32x32x16_bf16 v[64:79], v[108:111], v[104:107], v[64:79]
    s_waitcnt lgkmcnt(3)
    v_mfma_f32_32x32x16_bf16 v[64:79], v[116:119], v[112:115], v[64:79]
    s_waitcnt lgkmcnt(0)
    v_mfma_f32_32x32x16_bf16 v[64:79], v[124:127], v[120:123], v[64:79]
    s_waitcnt vmcnt(2)
    s_barrier
    s_add_u32 s20, s6, 40960
    s_add_u32 m0, s21, 147456
    s_nop 0
    buffer_load_dwordx4 v2, s[8:11], s20 offen lds
    s_add_u32 s20, s6, 98304
    s_add_u32 m0, s21, 155648
    s_nop 0
    buffer_load_dwordx4 v2, s[8:11], s20 offen lds
    ds_read_b128 v[96:99], v8 offset:0
    ds_read_b64_tr_b16 v[100:101], v9 offset:49152
    ds_read_b64_tr_b16 v[102:103], v9 offset:49664
    ds_read_b128 v[104:107], v8 offset:1024
    ds_read_b64_tr_b16 v[108:109], v9 offset:51200
    ds_read_b64_tr_b16 v[110:111], v9 offset:51712
    ds_read_b128 v[112:115], v8 offset:2048
    ds_read_b64_tr_b16 v[116:117], v9 offset:53248
    ds_read_b64_tr_b16 v[118:119], v9 offset:53760
    ds_read_b128 v[120:123], v8 offset:3072
    ds_read_b64_tr_b16 v[124:125], v9 offset:55296
    ds_read_b64_tr_b16 v[126:127], v9 offset:55808
    s_waitcnt lgkmcnt(9)
    v_mfma_f32_32x32x16_bf16 v[64:79], v[100:103], v[96:99], v[64:79]
    s_waitcnt lgkmcnt(6)
    v_mfma_f32_32x32x16_bf16 v[64:79], v[108:111], v[104:107], v[64:79]
    s_waitcnt lgkmcnt(3)
    v_mfma_f32_32x32x16_bf16 v[64:79], v[116:119], v[112:115], v[64:79]
    s_waitcnt lgkmcnt(0)
    v_mfma_f32_32x32x16_bf16 v[64:79], v[124:127], v[120:123], v[64:79]
    s_waitcnt vmcnt(2)
    s_barrier
    s_add_u32 s20, s6, 49152
    s_add_u32 m0, s21, 114688
    s_nop 0
    buffer_load_dwordx4 v2, s[8:11], s20 offen lds
    s_add_u32 s20, s6, 106496
    s_add_u32 m0, s21, 122880
    s_nop 0
    buffer_load_dwordx4 v2, s[8:11], s20 offen lds
    ds_read_b128 v[96:99], v8 offset:16384
    ds_read_b64_tr_b16 v[100:101], v10 offset:0
    ds_read_b64_tr_b16 v[102:103], v10 offset:512
    ds_read_b128 v[104:107], v8 offset:17408
    ds_read_b64_tr_b16 v[108:109], v10 offset:2048
    ds_read_b64_tr_b16 v[110:111], v10 offset:2560
    ds_read_b128 v[112:115], v8 offset:18432
    ds_read_b64_tr_b16 v[116:117], v10 offset:4096
    ds_read_b64_tr_b16 v[118:119], v10 offset:4608
    ds_read_b128 v[120:123], v8 offset:19456
    ds_read_b64_tr_b16 v[124:125], v10 offset:6144
    ds_read_b64_tr_b16 v[126:127], v10 offset:6656
    s_waitcnt lgkmcnt(9)
    v_mfma_f32_32x32x16_bf16 v[64:79], v[100:103], v[96:99], v[64:79]
    s_waitcnt lgkmcnt(6)
    v_mfma_f32_32x32x16_bf16 v[64:79], v[108:111], v[104:107], v[64:79]
    s_waitcnt lgkmcnt(3)
    v_mfma_f32_32x32x16_bf16 v[64:79], v[116:119], v[112:115], v[64:79]
    s_waitcnt lgkmcnt(0)
    v_mfma_f32_32x32x16_bf16 v[64:79], v[124:127], v[120:123], v[64:79]
    s_waitcnt vmcnt(2)
    s_barrier
    ds_read_b128 v[96:99], v8 offset:32768
    ds_read_b64_tr_b16 v[100:101], v10 offset:16384
    ds_read_b64_tr_b16 v[102:103], v10 offset:16896
    ds_read_b128 v[104:107], v8 offset:33792
    ds_read_b64_tr_b16 v[108:109], v10 offset:18432
    ds_read_b64_tr_b16 v[110:111], v10 offset:18944
    ds_read_b128 v[112:115], v8 offset:34816
    ds_read_b64_tr_b16 v[116:117], v10 offset:20480
    ds_read_b64_tr_b16 v[118:119], v10 offset:20992
    ds_read_b128 v[120:123], v8 offset:35840
    ds_read_b64_tr_b16 v[124:125], v10 offset:22528
    ds_read_b64_tr_b16 v[126:127], v10 offset:23040
    s_waitcnt lgkmcnt(9)
    v_mfma_f32_32x32x16_bf16 v[64:79], v[100:103], v[96:99], v[64:79]
    s_waitcnt lgkmcnt(6)
    v_mfma_f32_32x32x16_bf16 v[64:79], v[108:111], v[104:107], v[64:79]
    s_waitcnt lgkmcnt(3)
    v_mfma_f32_32x32x16_bf16 v[64:79], v[116:119], v[112:115], v[64:79]
    s_waitcnt lgkmcnt(0)
    v_mfma_f32_32x32x16_bf16 v[64:79], v[124:127], v[120:123], v[64:79]
    s_waitcnt vmcnt(0)
    s_barrier
    ds_read_b128 v[96:99], v8 offset:0
    ds_read_b64_tr_b16 v[100:101], v10 offset:32768
    ds_read_b64_tr_b16 v[102:103], v10 offset:33280
    ds_read_b128 v[104:107], v8 offset:1024
    ds_read_b64_tr_b16 v[108:109], v10 offset:34816
    ds_read_b64_tr_b16 v[110:111], v10 offset:35328
    ds_read_b128 v[112:115], v8 offset:2048
    ds_read_b64_tr_b16 v[116:117], v10 offset:36864
    ds_read_b64_tr_b16 v[118:119], v10 offset:37376
    ds_read_b128 v[120:123], v8 offset:3072
    ds_read_b64_tr_b16 v[124:125], v10 offset:38912
    ds_read_b64_tr_b16 v[126:127], v10 offset:39424
    s_waitcnt lgkmcnt(9)
    v_mfma_f32_32x32x16_bf16 v[64:79], v[100:103], v[96:99], v[64:79]
    s_waitcnt lgkmcnt(6)
    v_mfma_f32_32x32x16_bf16 v[64:79], v[108:111], v[104:107], v[64:79]
    s_waitcnt lgkmcnt(3)
    v_mfma_f32_32x32x16_bf16 v[64:79], v[116:119], v[112:115], v[64:79]
    s_waitcnt lgkmcnt(0)
    v_mfma_f32_32x32x16_bf16 v[64:79], v[124:127], v[120:123], v[64:79]
    s_barrier
    s_mul_i32 s20, s3, 4608
    v_and_b32 v18, 31, v1
    v_mul_u32_u24 v18, 144, v18
    v_lshrrev_b32 v19, 5, v1
    v_lshl_add_u32 v18, v19, 4, v18
    v_add_u32 v18, s20, v18
    s_nop 4
    ds_write_b128 v18, v[64:67] offset:0
    ds_write_b128 v18, v[68:71] offset:32
    ds_write_b128 v18, v[72:75] offset:64
    ds_write_b128 v18, v[76:79] offset:96
    s_waitcnt vmcnt(0)
    v_pk_add_f32 v[160:161], v[160:161], v[168:169]
    v_pk_add_f32 v[176:177], v[176:177], v[184:185]
    v_pk_add_f32 v[162:163], v[162:163], v[170:171]
    v_pk_add_f32 v[178:179], v[178:179], v[186:187]
    v_pk_add_f32 v[164:165], v[164:165], v[172:173]
    v_pk_add_f32 v[180:181], v[180:181], v[188:189]
    v_pk_add_f32 v[166:167], v[166:167], v[174:175]
    v_pk_add_f32 v[182:183], v[182:183], v[190:191]
    v_pk_add_f32 v[160:161], v[160:161], v[176:177]
    v_pk_add_f32 v[162:163], v[162:163], v[178:179]
    v_pk_add_f32 v[164:165], v[164:165], v[180:181]
    v_pk_add_f32 v[166:167], v[166:167], v[182:183]
    v_cvt_pk_bf16_f32 v168, v160, v161
    v_cvt_pk_bf16_f32 v169, v162, v163
    v_cvt_pk_bf16_f32 v170, v164, v165
    v_cvt_pk_bf16_f32 v171, v166, v167
    v_lshlrev_b32 v160, 16, v168
    v_and_b32 v161, 0xffff0000, v168
    v_lshlrev_b32 v162, 16, v169
    v_and_b32 v163, 0xffff0000, v169
    v_lshlrev_b32 v164, 16, v170
    v_and_b32 v165, 0xffff0000, v170
    v_lshlrev_b32 v166, 16, v171
    v_and_b32 v167, 0xffff0000, v171
    s_and_b32 s20, s3, 3
    s_mul_i32 s20, s20, 4608
    s_lshr_b32 s21, s3, 2
    s_mul_i32 s21, s21, 2304
    s_add_u32 s20, s20, s21
    v_mul_u32_u24 v18, 144, v14
    v_lshl_add_u32 v18, v15, 5, v18
    v_add_u32 v18, s20, v18
    s_waitcnt lgkmcnt(0)
    s_barrier
    ds_read_b128 v[48:51], v18
    ds_read_b128 v[52:55], v18 offset:16
    ds_read_b128 v[56:59], v18 offset:18432
    ds_read_b128 v[60:63], v18 offset:18448
    s_waitcnt lgkmcnt(0)
    v_pk_add_f32 v[48:49], v[48:49], v[56:57]
    v_pk_add_f32 v[50:51], v[50:51], v[58:59]
    v_pk_add_f32 v[52:53], v[52:53], v[60:61]
    v_pk_add_f32 v[54:55], v[54:55], v[62:63]
    v_lshlrev_b32 v56, 16, v32
    v_and_b32 v57, 0xffff0000, v32
    v_lshlrev_b32 v58, 16, v33
    v_and_b32 v59, 0xffff0000, v33
    v_lshlrev_b32 v60, 16, v34
    v_and_b32 v61, 0xffff0000, v34
    v_lshlrev_b32 v62, 16, v35
    v_and_b32 v63, 0xffff0000, v35
    v_pk_fma_f32 v[56:57], v[160:161], v[48:49], v[56:57]
    v_pk_fma_f32 v[58:59], v[162:163], v[50:51], v[58:59]
    v_pk_fma_f32 v[60:61], v[164:165], v[52:53], v[60:61]
    v_pk_fma_f32 v[62:63], v[166:167], v[54:55], v[62:63]
    v_cvt_pk_bf16_f32 v32, v56, v57
    v_cvt_pk_bf16_f32 v33, v58, v59
    v_cvt_pk_bf16_f32 v34, v60, v61
    v_cvt_pk_bf16_f32 v35, v62, v63
    buffer_store_dwordx4 v[32:35], v16, s[24:27], s32 offen
L_exit:
    s_endpgm
.section .rodata,"a"
.p2align 6
.amdhsa_kernel adaLN_cond__softmax_full_mha__mixer_gmlp__prompt_kernel
  .amdhsa_next_free_vgpr 256
  .amdhsa_next_free_sgpr 102
  .amdhsa_accum_offset 256
  .amdhsa_group_segment_fixed_size 0
  .amdhsa_kernarg_size 104
  .amdhsa_user_sgpr_count 2
  .amdhsa_user_sgpr_kernarg_segment_ptr 1
  .amdhsa_system_sgpr_workgroup_id_x 1
.end_amdhsa_kernel
```
